```python
import torch

def _softmax(x, axis=-1):
    return torch.softmax(x, dim=axis)
def _gelu(x):
    return torch.nn.functional.gelu(x, approximate="tanh")
def _silu(x):
    return torch.nn.functional.silu(x)
def _sigmoid(x):
    return torch.sigmoid(x)
def _layernorm(x, axis=-1, eps=1e-5):
    m = x.mean(dim=axis, keepdim=True)
    v = x.var(dim=axis, keepdim=True, unbiased=False)
    return (x - m) / torch.sqrt(v + eps)
def _scatter_add(tgt, idx, src, axis=0):
    return tgt.clone().index_add_(axis, idx, src)
def _segment_sum(src, seg, n):
    out = torch.zeros((n,) + src.shape[1:], dtype=src.dtype)
    return out.index_add_(0, seg, src)
def _pad(x, pw):
    flat = tuple(v for pair in reversed(pw) for v in pair)
    return torch.nn.functional.pad(x, flat)

kernel_name = 'parallel_sum__spectral_gfnet__mixer_channel_mlp__prompt'

def setup_inputs():

    _w = (lambda a: (lambda t: t.to(torch.bfloat16) if t.is_floating_point() else t)(torch.as_tensor(a)))
    def _A_setup():
        B, S, D = 1, 2048, 512
        Df = D // 2 + 1
        return {
            "x": _w((lambda *s: torch.randn(*s, dtype=torch.bfloat16) * 0.05)(B, S, D)),
            "w_r": _w((lambda *s: torch.randn(*s, dtype=torch.bfloat16) * 0.8)(S, Df) * 0.02),
            "w_i": _w((lambda *s: torch.randn(*s, dtype=torch.bfloat16) * 0.8)(S, Df) * 0.02),
        }
    _A_in = _A_setup()

    def _B_setup():
        B, S, D, F = 1, 2048, 512, 1792
        return {
            "x": _w((lambda *s: torch.randn(*s, dtype=torch.bfloat16) * 0.05)(B, S, D)),
            "w1": _w((lambda *s: torch.randn(*s, dtype=torch.bfloat16) * 0.8)(D, F) * (D ** -0.5)),
            "b1": _w((lambda *s: torch.randn(*s, dtype=torch.bfloat16) * 0.4)(F)),
            "w2": _w((lambda *s: torch.randn(*s, dtype=torch.bfloat16) * 0.05)(F, D) * (F ** -0.5)),
            "b2": _w((lambda *s: torch.randn(*s, dtype=torch.bfloat16) * 0.05)(D)),
        }
    _B_in = _B_setup()

    return {
        "A_x": _A_in["x"],
        "A_w_r": _A_in["w_r"],
        "A_w_i": _A_in["w_i"],
        "B_x": _B_in["x"],
        "B_w1": _B_in["w1"],
        "B_b1": _B_in["b1"],
        "B_w2": _B_in["w2"],
        "B_b2": _B_in["b2"],
    }

def reference(A_x, A_w_r, A_w_i, B_x, B_w1, B_b1, B_w2, B_b2):
    def _A_ref(x, w_r, w_i):
        B, S, D = x.shape
        X = (lambda x, axes=(-2,-1): torch.fft.rfft2(x.float(), dim=axes))(x, axes=(-2, -1))
        W = w_r + 1j * w_i
        X = X * W
        y = (lambda x, s, axes=(-2,-1): torch.fft.irfft2(x, s=s, dim=axes).to(torch.bfloat16))(X, (S, D), axes=(-2, -1))
        return y

    def _B_ref(x, w1, b1, w2, b2):
        y = _layernorm(x, axis=-1)
        h = _gelu(torch.einsum("bsd,df->bsf", y, w1) + b1)
        return torch.einsum("bsf,fd->bsd", h, w2) + b2

    x = A_x
    xn = _layernorm(x, axis=-1)
    return x + _A_ref(xn, A_w_r, A_w_i) + _B_ref(xn, B_w1, B_b1, B_w2, B_b2)
```

```asm
; @launch grid=(256,1,1) block=(512,1,1) lds=163840
.amdgcn_target "amdgcn-amd-amdhsa--gfx950"
.text
.globl parallel_sum__spectral_gfnet__mixer_channel_mlp__prompt_kernel
.p2align 8
.type parallel_sum__spectral_gfnet__mixer_channel_mlp__prompt_kernel,@function
parallel_sum__spectral_gfnet__mixer_channel_mlp__prompt_kernel:
    s_cmp_ge_u32 s2, 256
    s_cbranch_scc1 L_end
    s_load_dwordx2 s[4:5], s[0:1], 0
    s_load_dwordx2 s[8:9], s[0:1], 32
    s_load_dwordx2 s[12:13], s[0:1], 80
    s_load_dwordx2 s[24:25], s[0:1], 48
    s_getpc_b64 s[54:55]
    v_lshlrev_b32 v4, 6, v0
    v_min_u32 v4, L_end-parallel_sum__spectral_gfnet__mixer_channel_mlp__prompt_kernel-64, v4
    v_mov_b32 v5, s55
    v_add_co_u32 v4, vcc, s54, v4
    s_nop 1
    v_addc_co_u32 v5, vcc, 0, v5, vcc
    global_load_dword v10, v[4:5], off
    v_lshrrev_b32 v3, 6, v0
    v_and_b32 v0, 63, v0
    v_readfirstlane_b32 s44, v3
    v_and_b32 v1, 15, v0
    v_lshrrev_b32 v2, 4, v0
    s_bfe_u32 s45, s2, 0x20001
    s_bfe_u32 s52, s2, 0x20003
    s_lshl2_add_u32 s45, s45, s52
    s_and_b32 s46, s2, 1
    s_lshr_b32 s47, s2, 5
    s_mul_i32 s51, s46, 7
    s_add_u32 s51, s51, s47
    s_lshl1_add_u32 s59, s52, s47
    s_lshl_b32 s59, s59, 2
    s_mov_b32 s54, 0x21765321
    s_mov_b32 s55, 0x53217653
    s_lshr_b64 s[54:55], s[54:55], s59
    s_lshl_b32 s59, s54, 4
    s_add_u32 s52, s52, s47
    s_and_b32 s52, s52, 1
    s_lshl2_add_u32 s59, s52, s59
    s_lshl_b32 s58, s44, 12
    v_lshrrev_b32 v132, 3, v0
    v_and_b32 v133, 7, v0
    v_xor_b32 v134, v2, v133
    v_lshl_add_u32 v135, v3, 4, v132
    v_lshl_add_u32 v135, s45, 7, v135
    v_lshlrev_b32 v135, 10, v135
    v_lshl_add_u32 v4, v134, 4, v135
    v_xor_b32 v5, 64, v4
    v_add_u32 v5, 7168, v5
    v_and_b32 v136, 1, v3
    v_lshl_or_b32 v136, v136, 2, v2
    v_lshlrev_b32 v136, 1, v136
    v_xor_b32 v136, v136, v1
    v_lshl_add_u32 v137, v3, 3, v2
    v_mul_u32_u24 v138, 3584, v137
    v_lshl_add_u32 v138, v136, 4, v138
    v_lshl_add_u32 v138, s51, 8, v138
    v_add_u32 v6, 2048, v138
    v_add_u32 v7, 15360, v138
    s_mov_b32 s6, 2097152
    s_mov_b32 s7, 0x20000
    s_mov_b32 s10, 1839104
    s_mov_b32 s11, 0x20000
    s_waitcnt lgkmcnt(0)
    s_sub_u32 s8, s8, 4096
    s_subb_u32 s9, s9, 0
    s_cmp_eq_u32 s47, 7
    s_cbranch_scc1 L_typeF_1
    s_add_u32 m0, s58, 0
    s_bfe_u32 s56, s59, 196608
    s_mul_i32 s57, s56, 229376
    s_lshl_b32 s56, s56, 7
    buffer_load_dwordx4 v4, s[4:7], s56 offen offset:0 lds
    buffer_load_dwordx4 v5, s[4:7], s56 offen offset:1024 lds
    buffer_load_dwordx4 v6, s[8:11], s57 offen offset:2048 lds
    buffer_load_dwordx4 v7, s[8:11], s57 offen offset:3072 lds
    s_load_dwordx2 s[20:21], s[0:1], 40
    s_load_dwordx2 s[28:29], s[0:1], 56
    s_load_dwordx2 s[32:33], s[0:1], 64
    s_load_dwordx4 s[40:43], s[0:1], 8
    s_lshl3_add_u32 s50, s46, s47
    s_lshr_b32 s48, s44, 2
    s_and_b32 s49, s44, 3
    s_xor_b32 s73, s48, s46
    s_lshl1_add_u32 s62, s45, s46
    s_mov_b32 s65, s47
    s_mov_b32 s14, 18874368
    s_mov_b32 s15, 0x20000
    s_mov_b32 s26, 1835008
    s_mov_b32 s27, 0x20000
    s_add_u32 m0, s58, 32768
    s_bfe_u32 s56, s59, 196612
    s_mul_i32 s57, s56, 229376
    s_lshl_b32 s56, s56, 7
    buffer_load_dwordx4 v4, s[4:7], s56 offen offset:0 lds
    buffer_load_dwordx4 v5, s[4:7], s56 offen offset:1024 lds
    buffer_load_dwordx4 v6, s[8:11], s57 offen offset:2048 lds
    buffer_load_dwordx4 v7, s[8:11], s57 offen offset:3072 lds
    v_lshrrev_b32 v12, 1, v1
    v_lshl_add_u32 v12, s50, 3, v12
    v_add_u32 v12, 1, v12
    v_cvt_f32_u32 v12, v12
    v_mul_f32 v12, 0x3b000000, v12
    v_and_b32 v13, 1, v1
    v_cvt_f32_u32 v13, v13
    v_mul_f32 v13, 0x3e800000, v13
    s_lshr_b32 s52, s44, 1
    s_lshl_b32 s52, s52, 2
    s_lshr_b32 s52, s59, s52
    s_and_b32 s52, s52, 7
    s_and_b32 s53, s44, 1
    s_lshl1_add_u32 s52, s52, s53
    v_lshl_add_u32 v14, s52, 2, v2
    v_lshlrev_b32 v14, 3, v14
    v_cvt_f32_u32 v14, v14
    v_fma_f32 v14, v14, v12, v13
    v_lshlrev_b32 v15, 10, v3
    v_lshl_add_u32 v15, v0, 4, v15
    v_add_u32 v15, 131072, v15
    v_fmamk_f32 v20, v12, 0x00000000, v14
    v_fmamk_f32 v21, v12, 0x3f800000, v14
    v_fmamk_f32 v22, v12, 0x40000000, v14
    v_fmamk_f32 v23, v12, 0x40400000, v14
    v_fmamk_f32 v24, v12, 0x40800000, v14
    v_fmamk_f32 v25, v12, 0x40a00000, v14
    v_fmamk_f32 v26, v12, 0x40c00000, v14
    v_fmamk_f32 v27, v12, 0x40e00000, v14
    v_cos_f32 v20, v20
    v_cos_f32 v21, v21
    v_cos_f32 v22, v22
    v_cos_f32 v23, v23
    v_cos_f32 v24, v24
    v_cos_f32 v25, v25
    v_cos_f32 v26, v26
    v_cos_f32 v27, v27
    v_cvt_pk_bf16_f32 v16, v20, v21
    v_cvt_pk_bf16_f32 v17, v22, v23
    v_cvt_pk_bf16_f32 v18, v24, v25
    v_cvt_pk_bf16_f32 v19, v26, v27
    ds_write_b128 v15, v[16:19]
    v_lshrrev_b32 v88, 1, v1
    v_and_b32 v89, 4, v3
    v_or_b32 v90, v89, v2
    v_xor_b32 v88, v88, v90
    v_lshlrev_b32 v88, 4, v88
    v_lshl_add_u32 v88, v1, 7, v88
    v_lshl_add_u32 v88, s73, 12, v88
    v_and_b32 v91, 3, v3
    v_lshl_add_u32 v112, v91, 13, v88
    v_xor_b32 v113, 8192, v112
    v_xor_b32 v114, 16384, v112
    v_xor_b32 v115, 24576, v112
    v_xor_b32 v116, 64, v112
    v_xor_b32 v117, 64, v113
    v_xor_b32 v118, 64, v114
    v_xor_b32 v119, 64, v115
    v_lshrrev_b32 v88, 2, v1
    v_and_b32 v93, 3, v1
    v_and_b32 v92, 1, v2
    v_lshl_or_b32 v92, v92, 2, v88
    v_lshlrev_b32 v91, 1, v91
    v_xor_b32 v92, v91, v92
    v_lshlrev_b32 v88, 8, v88
    v_lshl_add_u32 v88, v90, 12, v88
    v_lshl_add_u32 v88, v92, 5, v88
    v_lshl_add_u32 v88, v93, 3, v88
    v_add_u32 v120, 2048, v88
    v_xor_b32 v121, 32, v120
    v_xor_b32 v122, 0x4000, v120
    v_xor_b32 v123, 0x4000, v121
    v_lshlrev_b32 v89, 8, v89
    v_lshl_add_u32 v89, v0, 4, v89
    v_add_u32 v8, 131072, v89
    v_xor_b32 v9, 0x400, v8
    v_mov_b32 v128, 0x3f803f80
    v_mov_b32 v129, 0x3f803f80
    v_mov_b32 v130, 0x3f803f80
    v_mov_b32 v131, 0x3f803f80
    s_waitcnt lgkmcnt(0)
    s_mul_i32 s80, s46, 28
    s_add_u32 s80, s80, s49
    v_lshl_add_u32 v141, s80, 5, v132
    v_lshlrev_b32 v141, 10, v141
    v_lshlrev_b32 v142, 1, v2
    v_xor_b32 v142, v142, v133
    v_lshl_add_u32 v141, v142, 4, v141
    v_lshl_add_u32 v252, s65, 7, v141
    s_cmp_eq_u32 s48, 0
    s_cselect_b64 s[16:17], s[40:41], s[42:43]
    s_mov_b32 s18, 1052672
    s_mov_b32 s19, 0x20000
    s_lshl2_add_u32 s80, s47, s49
    s_and_b32 s81, s2, 7
    s_lshl3_add_u32 s80, s80, s81
    s_mul_i32 s80, s80, 4112
    s_bfe_u32 s81, s2, 0x20003
    s_lshl_b32 s81, s81, 7
    s_add_u32 s80, s80, s81
    s_add_u32 s80, s80, 2
    v_xor_b32 v140, v132, v133
    v_mul_u32_u24 v141, 514, v132
    v_lshl_add_u32 v141, v140, 4, v141
    v_add_u32 v246, s80, v141
    v_xor_b32 v140, v3, v133
    v_lshlrev_b32 v140, 4, v140
    v_lshl_add_u32 v140, v133, 7, v140
    v_lshl_add_u32 v140, v132, 1, v140
    v_add_u32 v244, 139264, v140
    s_bfe_u32 s80, s2, 0x20003
    s_lshl3_add_u32 s80, s80, s44
    v_lshl_add_u32 v140, s80, 3, v132
    v_mul_u32_u24 v140, 8448, v140
    v_lshl_add_u32 v140, v133, 4, v140
    s_lshl_b32 s80, s80, 5
    s_bfe_u32 s81, s2, 0x20001
    s_add_u32 s80, s80, s81
    s_lshl3_add_u32 s80, s80, s47
    s_lshl1_add_u32 s80, s80, s46
    s_lshl3_add_u32 s80, s80, 14942208
    v_lshl_add_u32 v250, v0, 9, s80
    s_lshr_b32 s80, s2, 7
    s_bfe_u32 s81, s2, 0x20001
    s_lshl2_add_u32 s80, s80, s81
    s_bfe_u32 s81, s2, 0x20005
    s_lshl2_add_u32 s80, s80, s81
    s_lshl1_add_u32 s80, s80, s46
    s_lshl_b32 s80, s80, 7
    s_add_u32 s80, s80, 4718592
    v_add_u32 v245, s80, v140
    s_lshl3_add_u32 s80, s50, s44
    s_lshl4_add_u32 s80, s80, s45
    s_lshl_b32 s80, s80, 5
    s_add_u32 s80, s80, 14811136
    v_writelane_b32 v250, s80, 8
    s_add_u32 s80, s80, 16
    v_writelane_b32 v250, s80, 9
    s_lshl1_add_u32 s66, s45, s73
    s_lshl_b32 s80, s62, 6
    s_add_u32 s80, s80, s44
    s_lshl3_add_u32 s80, s80, s47
    s_lshl4_add_u32 s80, s80, 15204352
    v_lshl_add_u32 v254, v0, 10, s80
    s_lshl_b32 s66, s66, 8
    v_lshrrev_b32 v140, 2, v1
    v_lshl_add_u32 v140, v140, 4, v1
    v_lshlrev_b32 v247, 2, v140
    s_lshl1_add_u32 s80, s49, s48
    s_lshl_b32 s80, s80, 8
    s_add_u32 s80, s80, 153600
    v_lshl_add_u32 v248, v1, 4, s80
    s_lshl_b32 s80, s73, 8
    s_lshl2_add_u32 s80, s49, s80
    s_add_u32 s80, s80, 147456
    v_lshlrev_b32 v140, 10, v2
    v_lshl_add_u32 v140, v1, 4, v140
    v_add_u32 v249, s80, v140
    v_and_b32 v140, 3, v1
    v_cmp_eq_u32 s[74:75], 1, v140
    v_cmp_eq_u32 s[76:77], 2, v140
    v_cmp_eq_u32 s[78:79], 3, v140
    s_lshl3_add_u32 s72, s50, s44
    s_mul_i32 s72, s72, 8448
    s_lshl_b32 s80, s45, 9
    s_add_u32 s72, s72, s80
    v_mov_b32 v140, 152576
    v_mov_b32 v144, 0
    v_mov_b32 v145, 0
    v_mov_b32 v146, 0
    v_mov_b32 v147, 0
    ds_write_b128 v140, v[144:147]
    ds_write_b128 v140, v[144:147] offset:16
    ds_write_b128 v140, v[144:147] offset:32
    s_cmp_ge_u32 s44, 4
    s_cbranch_scc1 L_ce_3
    v_lshl_add_u32 v20, v3, 4, v1
    v_cvt_f32_u32 v20, v20
    v_lshlrev_b32 v21, 2, v2
    v_cvt_f32_u32 v21, v21
    v_cvt_f32_u32 v22, v1
    v_and_b32 v26, 1, v1
    v_mul_u32_u24 v26, 0x8000, v26
    v_lshl_or_b32 v26, v26, 16, v26
    v_mul_f32 v23, 0x3c800000, v20
    v_mul_f32 v24, v23, v21
    v_fmamk_f32 v12, v23, 0x00000000, v24
    v_fmamk_f32 v13, v23, 0x3f800000, v24
    v_fmamk_f32 v14, v23, 0x40000000, v24
    v_fmamk_f32 v15, v23, 0x40400000, v24
    v_cos_f32 v16, v12
    v_sin_f32 v12, v12
    v_cos_f32 v17, v13
    v_sin_f32 v13, v13
    v_cos_f32 v18, v14
    v_sin_f32 v14, v14
    v_cos_f32 v19, v15
    v_sin_f32 v15, v15
    v_cvt_pk_bf16_f32 v156, v16, v12
    v_cvt_pk_bf16_f32 v172, -v12, v16
    v_cvt_pk_bf16_f32 v157, v17, v13
    v_cvt_pk_bf16_f32 v173, -v13, v17
    v_cvt_pk_bf16_f32 v158, v18, v14
    v_cvt_pk_bf16_f32 v174, -v14, v18
    v_cvt_pk_bf16_f32 v159, v19, v15
    v_cvt_pk_bf16_f32 v175, -v15, v19
    v_fmamk_f32 v12, v23, 0x41800000, v24
    v_fmamk_f32 v13, v23, 0x41880000, v24
    v_fmamk_f32 v14, v23, 0x41900000, v24
    v_fmamk_f32 v15, v23, 0x41980000, v24
    v_cos_f32 v16, v12
    v_sin_f32 v12, v12
    v_cos_f32 v17, v13
    v_sin_f32 v13, v13
    v_cos_f32 v18, v14
    v_sin_f32 v14, v14
    v_cos_f32 v19, v15
    v_sin_f32 v15, v15
    v_cvt_pk_bf16_f32 v160, v16, v12
    v_cvt_pk_bf16_f32 v176, -v12, v16
    v_cvt_pk_bf16_f32 v161, v17, v13
    v_cvt_pk_bf16_f32 v177, -v13, v17
    v_cvt_pk_bf16_f32 v162, v18, v14
    v_cvt_pk_bf16_f32 v178, -v14, v18
    v_cvt_pk_bf16_f32 v163, v19, v15
    v_cvt_pk_bf16_f32 v179, -v15, v19
    v_xor_b32 v164, v26, v156
    v_xor_b32 v165, v26, v157
    v_xor_b32 v166, v26, v158
    v_xor_b32 v167, v26, v159
    v_xor_b32 v168, v26, v160
    v_xor_b32 v169, v26, v161
    v_xor_b32 v170, v26, v162
    v_xor_b32 v171, v26, v163
    v_xor_b32 v180, v26, v172
    v_xor_b32 v181, v26, v173
    v_xor_b32 v182, v26, v174
    v_xor_b32 v183, v26, v175
    v_xor_b32 v184, v26, v176
    v_xor_b32 v185, v26, v177
    v_xor_b32 v186, v26, v178
    v_xor_b32 v187, v26, v179
    v_mul_f32 v23, 0x3a000000, v20
    v_mul_f32 v24, v23, v21
    v_fmamk_f32 v196, v23, 0x00000000, v24
    v_fmamk_f32 v197, v23, 0x3f800000, v24
    v_fmamk_f32 v198, v23, 0x40000000, v24
    v_fmamk_f32 v199, v23, 0x40400000, v24
    v_fmamk_f32 v200, v23, 0x41800000, v24
    v_fmamk_f32 v201, v23, 0x41880000, v24
    v_fmamk_f32 v202, v23, 0x41900000, v24
    v_fmamk_f32 v203, v23, 0x41980000, v24
    v_cos_f32 v188, v196
    v_sin_f32 v196, v196
    v_cos_f32 v189, v197
    v_sin_f32 v197, v197
    v_cos_f32 v190, v198
    v_sin_f32 v198, v198
    v_cos_f32 v191, v199
    v_sin_f32 v199, v199
    v_cos_f32 v192, v200
    v_sin_f32 v200, v200
    v_cos_f32 v193, v201
    v_sin_f32 v201, v201
    v_cos_f32 v194, v202
    v_sin_f32 v202, v202
    v_cos_f32 v195, v203
    v_sin_f32 v203, v203
    v_mul_f32 v23, 0x3d000000, v22
    v_mul_f32 v24, v23, v21
    v_fmamk_f32 v12, v23, 0x00000000, v24
    v_fmamk_f32 v13, v23, 0x3f800000, v24
    v_fmamk_f32 v14, v23, 0x40000000, v24
    v_fmamk_f32 v15, v23, 0x40400000, v24
    v_cos_f32 v16, v12
    v_sin_f32 v12, v12
    v_cos_f32 v17, v13
    v_sin_f32 v13, v13
    v_cos_f32 v18, v14
    v_sin_f32 v14, v14
    v_cos_f32 v19, v15
    v_sin_f32 v15, v15
    v_cvt_pk_bf16_f32 v220, v16, v12
    v_cvt_pk_bf16_f32 v224, -v12, v16
    v_mov_b32 v228, v220
    v_mov_b32 v232, v224
    v_cvt_pk_bf16_f32 v221, v17, v13
    v_cvt_pk_bf16_f32 v225, -v13, v17
    v_xor_b32 v229, 0x80008000, v221
    v_xor_b32 v233, 0x80008000, v225
    v_cvt_pk_bf16_f32 v222, v18, v14
    v_cvt_pk_bf16_f32 v226, -v14, v18
    v_mov_b32 v230, v222
    v_mov_b32 v234, v226
    v_cvt_pk_bf16_f32 v223, v19, v15
    v_cvt_pk_bf16_f32 v227, -v15, v19
    v_xor_b32 v231, 0x80008000, v223
    v_xor_b32 v235, 0x80008000, v227
    v_lshlrev_b32 v25, 4, v3
    v_cvt_f32_u32 v25, v25
    v_add_f32 v25, v25, v21
    s_cmp_eq_u32 s2, 255
    s_mov_b32 s52, 0x36000000
    s_cselect_b32 s52, 0x35800000, s52
    v_add_f32 v23, 0x00000000, v22
    v_mul_f32 v23, 0x3a000000, v23
    v_mul_f32 v24, v23, v25
    v_fmamk_f32 v212, v23, 0x00000000, v24
    v_fmamk_f32 v213, v23, 0x3f800000, v24
    v_fmamk_f32 v214, v23, 0x40000000, v24
    v_fmamk_f32 v215, v23, 0x40400000, v24
    v_add_f32 v23, 0x41800000, v22
    v_mul_f32 v23, 0x3a000000, v23
    v_mul_f32 v24, v23, v25
    v_fmamk_f32 v216, v23, 0x00000000, v24
    v_fmamk_f32 v217, v23, 0x3f800000, v24
    v_fmamk_f32 v218, v23, 0x40000000, v24
    v_fmamk_f32 v219, v23, 0x40400000, v24
    v_cos_f32 v204, v212
    v_sin_f32 v212, v212
    v_cos_f32 v205, v213
    v_sin_f32 v213, v213
    v_cos_f32 v206, v214
    v_sin_f32 v214, v214
    v_cos_f32 v207, v215
    v_sin_f32 v215, v215
    v_cos_f32 v208, v216
    v_sin_f32 v216, v216
    v_cos_f32 v209, v217
    v_sin_f32 v217, v217
    v_cos_f32 v210, v218
    v_sin_f32 v218, v218
    v_cos_f32 v211, v219
    v_sin_f32 v219, v219
    v_mul_f32 v204, s52, v204
    v_mul_f32 v205, s52, v205
    v_mul_f32 v206, s52, v206
    v_mul_f32 v207, s52, v207
    v_mul_f32 v208, s52, v208
    v_mul_f32 v209, s52, v209
    v_mul_f32 v210, s52, v210
    v_mul_f32 v211, s52, v211
    v_mul_f32 v212, s52, v212
    v_mul_f32 v213, s52, v213
    v_mul_f32 v214, s52, v214
    v_mul_f32 v215, s52, v215
    v_mul_f32 v216, s52, v216
    v_mul_f32 v217, s52, v217
    v_mul_f32 v218, s52, v218
    v_mul_f32 v219, s52, v219
L_ce_3:
    s_add_u32 m0, s58, 65536
    s_bfe_u32 s56, s59, 196616
    s_mul_i32 s57, s56, 229376
    s_lshl_b32 s56, s56, 7
    buffer_load_dwordx4 v4, s[4:7], s56 offen offset:0 lds
    buffer_load_dwordx4 v5, s[4:7], s56 offen offset:1024 lds
    buffer_load_dwordx4 v6, s[8:11], s57 offen offset:2048 lds
    buffer_load_dwordx4 v7, s[8:11], s57 offen offset:3072 lds
    v_mov_b32 v255, 14680064
    buffer_load_dword v255, v255, s[12:15], 0 offen sc1
    s_waitcnt vmcnt(9)
    s_waitcnt lgkmcnt(0)
    s_barrier
    ds_read_b64_tr_b16 v[88:89], v120 offset:0
    ds_read_b64_tr_b16 v[90:91], v120 offset:1024
    ds_read_b128 v[12:15], v112 offset:0
    ds_read_b64_tr_b16 v[92:93], v121 offset:0
    ds_read_b64_tr_b16 v[94:95], v121 offset:1024
    ds_read_b128 v[16:19], v113 offset:0
    ds_read_b128 v[20:23], v114 offset:0
    ds_read_b128 v[24:27], v115 offset:0
    ds_read_b128 v[104:107], v8 offset:0
    s_waitcnt lgkmcnt(0)
    v_mfma_f32_16x16x32_bf16 v[44:47], v[88:91], v[12:15], 0
    ds_read_b64_tr_b16 v[96:97], v122 offset:0
    v_mfma_f32_16x16x32_bf16 v[48:51], v[92:95], v[12:15], 0
    ds_read_b64_tr_b16 v[98:99], v122 offset:1024
    s_add_u32 m0, s58, 98304
    s_bfe_u32 s56, s59, 196620
    s_mul_i32 s57, s56, 229376
    s_lshl_b32 s56, s56, 7
    buffer_load_dwordx4 v4, s[4:7], s56 offen offset:0 lds
    v_mfma_f32_16x16x32_bf16 v[52:55], v[88:91], v[16:19], 0
    ds_read_b128 v[28:31], v116 offset:0
    v_mfma_f32_16x16x32_bf16 v[56:59], v[92:95], v[16:19], 0
    ds_read_b64_tr_b16 v[100:101], v123 offset:0
    v_mfma_f32_16x16x32_bf16 v[60:63], v[88:91], v[20:23], 0
    ds_read_b64_tr_b16 v[102:103], v123 offset:1024
    buffer_load_dwordx4 v5, s[4:7], s56 offen offset:1024 lds
    v_mfma_f32_16x16x32_bf16 v[64:67], v[92:95], v[20:23], 0
    ds_read_b128 v[32:35], v117 offset:0
    v_mfma_f32_16x16x32_bf16 v[68:71], v[88:91], v[24:27], 0
    ds_read_b128 v[36:39], v118 offset:0
    v_mfma_f32_16x16x32_bf16 v[72:75], v[92:95], v[24:27], 0
    ds_read_b128 v[40:43], v119 offset:0
    v_mfma_f32_16x16x32_bf16 v[152:155], v[12:15], v[12:15], 0
    ds_read_b128 v[108:111], v9 offset:0
    buffer_load_dwordx4 v6, s[8:11], s57 offen offset:2048 lds
    v_mfma_f32_16x16x32_bf16 v[148:151], v[128:131], v[12:15], 0
    v_mfma_f32_16x16x32_bf16 v[76:79], v[104:107], v[12:15], 0
    v_mfma_f32_16x16x32_bf16 v[80:83], v[88:91], v[128:131], 0
    buffer_load_dwordx4 v7, s[8:11], s57 offen offset:3072 lds
    v_mfma_f32_16x16x32_bf16 v[84:87], v[92:95], v[128:131], 0
    s_waitcnt vmcnt(9)
    s_waitcnt lgkmcnt(0)
    s_barrier
    v_mfma_f32_16x16x32_bf16 v[44:47], v[96:99], v[28:31], v[44:47]
    ds_read_b64_tr_b16 v[88:89], v120 offset:32768
    v_mfma_f32_16x16x32_bf16 v[48:51], v[100:103], v[28:31], v[48:51]
    ds_read_b64_tr_b16 v[90:91], v120 offset:33792
    v_mfma_f32_16x16x32_bf16 v[52:55], v[96:99], v[32:35], v[52:55]
    ds_read_b128 v[12:15], v112 offset:32768
    s_add_u32 m0, s58, 0
    s_bfe_u32 s56, s59, 196608
    s_xor_b32 s56, s56, 4
    s_mul_i32 s57, s56, 229376
    s_lshl_b32 s56, s56, 7
    buffer_load_dwordx4 v4, s[4:7], s56 offen offset:0 lds
    v_mfma_f32_16x16x32_bf16 v[56:59], v[100:103], v[32:35], v[56:59]
    ds_read_b64_tr_b16 v[92:93], v121 offset:32768
    v_mfma_f32_16x16x32_bf16 v[60:63], v[96:99], v[36:39], v[60:63]
    ds_read_b64_tr_b16 v[94:95], v121 offset:33792
    v_mfma_f32_16x16x32_bf16 v[64:67], v[100:103], v[36:39], v[64:67]
    ds_read_b128 v[16:19], v113 offset:32768
    v_mfma_f32_16x16x32_bf16 v[68:71], v[96:99], v[40:43], v[68:71]
    ds_read_b128 v[20:23], v114 offset:32768
    v_mfma_f32_16x16x32_bf16 v[72:75], v[100:103], v[40:43], v[72:75]
    ds_read_b128 v[24:27], v115 offset:32768
    v_mfma_f32_16x16x32_bf16 v[152:155], v[28:31], v[28:31], v[152:155]
    ds_read_b128 v[104:107], v8 offset:2048
    buffer_load_dwordx4 v5, s[4:7], s56 offen offset:1024 lds
    v_mfma_f32_16x16x32_bf16 v[148:151], v[128:131], v[28:31], v[148:151]
    v_mfma_f32_16x16x32_bf16 v[76:79], v[108:111], v[28:31], v[76:79]
    s_waitcnt lgkmcnt(0)
    v_mfma_f32_16x16x32_bf16 v[44:47], v[88:91], v[12:15], v[44:47]
    ds_read_b64_tr_b16 v[96:97], v122 offset:32768
    v_mfma_f32_16x16x32_bf16 v[48:51], v[92:95], v[12:15], v[48:51]
    ds_read_b64_tr_b16 v[98:99], v122 offset:33792
    s_mov_b32 s22, 3584
    s_mov_b32 s23, 0x20000
    s_lshl2_add_u32 s52, s51, s49
    s_lshl_b32 s52, s52, 6
    v_lshlrev_b32 v139, 3, v2
    buffer_load_dwordx2 v[124:125], v139, s[20:23], s52 offen
    buffer_load_dwordx2 v[126:127], v139, s[20:23], s52 offen offset:32
    v_mfma_f32_16x16x32_bf16 v[52:55], v[88:91], v[16:19], v[52:55]
    ds_read_b128 v[28:31], v116 offset:32768
    v_mfma_f32_16x16x32_bf16 v[56:59], v[92:95], v[16:19], v[56:59]
    ds_read_b64_tr_b16 v[100:101], v123 offset:32768
    buffer_load_dwordx4 v6, s[8:11], s57 offen offset:2048 lds
    v_mfma_f32_16x16x32_bf16 v[60:63], v[88:91], v[20:23], v[60:63]
    ds_read_b64_tr_b16 v[102:103], v123 offset:33792
    v_mfma_f32_16x16x32_bf16 v[64:67], v[92:95], v[20:23], v[64:67]
    ds_read_b128 v[32:35], v117 offset:32768
    v_mfma_f32_16x16x32_bf16 v[68:71], v[88:91], v[24:27], v[68:71]
    ds_read_b128 v[36:39], v118 offset:32768
    buffer_load_dwordx4 v7, s[8:11], s57 offen offset:3072 lds
    v_mfma_f32_16x16x32_bf16 v[72:75], v[92:95], v[24:27], v[72:75]
    ds_read_b128 v[40:43], v119 offset:32768
    v_mfma_f32_16x16x32_bf16 v[152:155], v[12:15], v[12:15], v[152:155]
    ds_read_b128 v[108:111], v9 offset:2048
    v_mfma_f32_16x16x32_bf16 v[148:151], v[128:131], v[12:15], v[148:151]
    s_lshl3_add_u32 s52, s2, s44
    s_mul_i32 s52, s52, 896
    v_lshlrev_b32 v11, 7, v0
    s_mov_b64 exec, 0x7f
    buffer_load_dword v10, v11, s[24:27], s52 offen
    s_mov_b64 exec, -1
    v_mfma_f32_16x16x32_bf16 v[76:79], v[104:107], v[12:15], v[76:79]
    v_mfma_f32_16x16x32_bf16 v[80:83], v[88:91], v[128:131], v[80:83]
    s_lshr_b32 s52, s58, 2
    s_add_u32 m0, s52, 139264
    s_nop 0
    buffer_load_dwordx4 v246, s[16:19], 0 offen lds
    v_mfma_f32_16x16x32_bf16 v[84:87], v[92:95], v[128:131], v[84:87]
    s_waitcnt vmcnt(13)
    s_waitcnt lgkmcnt(0)
    s_barrier
    v_xor_b32 v112, 0x10000, v112
    v_xor_b32 v113, 0x10000, v113
    v_xor_b32 v114, 0x10000, v114
    v_xor_b32 v115, 0x10000, v115
    v_xor_b32 v120, 0x10000, v120
    v_xor_b32 v121, 0x10000, v121
    v_mfma_f32_16x16x32_bf16 v[44:47], v[96:99], v[28:31], v[44:47]
    ds_read_b64_tr_b16 v[88:89], v120 offset:0
    s_cmp_eq_u32 s47, 7
    s_cselect_b32 s36, 0, s47
    v_mfma_f32_16x16x32_bf16 v[48:51], v[100:103], v[28:31], v[48:51]
    ds_read_b64_tr_b16 v[90:91], v120 offset:1024
    s_lshl_b32 s36, s36, 14
    v_mfma_f32_16x16x32_bf16 v[52:55], v[96:99], v[32:35], v[52:55]
    ds_read_b128 v[12:15], v112 offset:0
    s_add_u32 m0, s58, 32768
    s_bfe_u32 s56, s59, 196612
    s_xor_b32 s56, s56, 4
    s_mul_i32 s57, s56, 229376
    s_lshl_b32 s56, s56, 7
    buffer_load_dwordx4 v4, s[4:7], s56 offen offset:0 lds
    s_add_u32 s37, s36, 16384
    v_mfma_f32_16x16x32_bf16 v[56:59], v[100:103], v[32:35], v[56:59]
    ds_read_b64_tr_b16 v[92:93], v121 offset:0
    s_cmp_eq_u32 s37, 114688
    s_cselect_b32 s37, 0, s37
    v_mfma_f32_16x16x32_bf16 v[60:63], v[96:99], v[36:39], v[60:63]
    ds_read_b64_tr_b16 v[94:95], v121 offset:1024
    s_add_u32 s38, s37, 16384
    v_mfma_f32_16x16x32_bf16 v[64:67], v[100:103], v[36:39], v[64:67]
    ds_read_b128 v[16:19], v113 offset:0
    s_cmp_eq_u32 s38, 114688
    s_cselect_b32 s38, 0, s38
    v_mfma_f32_16x16x32_bf16 v[68:71], v[96:99], v[40:43], v[68:71]
    ds_read_b128 v[20:23], v114 offset:0
    s_add_u32 s39, s38, 16384
    v_mfma_f32_16x16x32_bf16 v[72:75], v[100:103], v[40:43], v[72:75]
    ds_read_b128 v[24:27], v115 offset:0
    s_cmp_eq_u32 s39, 114688
    s_cselect_b32 s39, 0, s39
    v_mfma_f32_16x16x32_bf16 v[152:155], v[28:31], v[28:31], v[152:155]
    ds_read_b128 v[104:107], v8 offset:4096
    buffer_load_dwordx4 v5, s[4:7], s56 offen offset:1024 lds
    v_mfma_f32_16x16x32_bf16 v[148:151], v[128:131], v[28:31], v[148:151]
    v_mfma_f32_16x16x32_bf16 v[76:79], v[108:111], v[28:31], v[76:79]
    v_xor_b32 v116, 0x10000, v116
    v_xor_b32 v117, 0x10000, v117
    v_xor_b32 v118, 0x10000, v118
    v_xor_b32 v119, 0x10000, v119
    v_xor_b32 v122, 0x10000, v122
    v_xor_b32 v123, 0x10000, v123
    s_waitcnt lgkmcnt(0)
    v_mfma_f32_16x16x32_bf16 v[44:47], v[88:91], v[12:15], v[44:47]
    ds_read_b64_tr_b16 v[96:97], v122 offset:0
    s_add_u32 s60, s39, 16384
    v_mfma_f32_16x16x32_bf16 v[48:51], v[92:95], v[12:15], v[48:51]
    ds_read_b64_tr_b16 v[98:99], v122 offset:1024
    s_cmp_eq_u32 s60, 114688
    s_cselect_b32 s60, 0, s60
    v_mfma_f32_16x16x32_bf16 v[52:55], v[88:91], v[16:19], v[52:55]
    ds_read_b128 v[28:31], v116 offset:0
    s_add_u32 s67, s60, 16384
    v_mfma_f32_16x16x32_bf16 v[56:59], v[92:95], v[16:19], v[56:59]
    ds_read_b64_tr_b16 v[100:101], v123 offset:0
    buffer_load_dwordx4 v6, s[8:11], s57 offen offset:2048 lds
    s_cmp_eq_u32 s67, 114688
    s_cselect_b32 s67, 0, s67
    v_mfma_f32_16x16x32_bf16 v[60:63], v[88:91], v[20:23], v[60:63]
    ds_read_b64_tr_b16 v[102:103], v123 offset:1024
    s_add_u32 s70, s67, 16384
    v_mfma_f32_16x16x32_bf16 v[64:67], v[92:95], v[20:23], v[64:67]
    ds_read_b128 v[32:35], v117 offset:0
    s_cmp_eq_u32 s70, 114688
    s_cselect_b32 s70, 0, s70
    v_mfma_f32_16x16x32_bf16 v[68:71], v[88:91], v[24:27], v[68:71]
    ds_read_b128 v[36:39], v118 offset:0
    s_cmp_eq_u32 s48, 0
    s_cselect_b32 s82, s39, s36
    s_cselect_b32 s83, s60, s37
    s_cselect_b32 s84, s67, s38
    s_cselect_b32 s85, s70, s39
    v_mfma_f32_16x16x32_bf16 v[72:75], v[92:95], v[24:27], v[72:75]
    ds_read_b128 v[40:43], v119 offset:0
    v_mfma_f32_16x16x32_bf16 v[152:155], v[12:15], v[12:15], v[152:155]
    ds_read_b128 v[108:111], v9 offset:4096
    v_mfma_f32_16x16x32_bf16 v[148:151], v[128:131], v[12:15], v[148:151]
    buffer_load_dwordx4 v7, s[8:11], s57 offen offset:3072 lds
    v_mfma_f32_16x16x32_bf16 v[76:79], v[104:107], v[12:15], v[76:79]
    v_mfma_f32_16x16x32_bf16 v[80:83], v[88:91], v[128:131], v[80:83]
    v_mfma_f32_16x16x32_bf16 v[84:87], v[92:95], v[128:131], v[84:87]
    s_waitcnt vmcnt(12)
    s_mov_b32 s52, 0x9e3779b1
    v_mul_lo_u32 v255, v255, s52
    v_add_u32 v255, 0x632be5ab, v255
    s_waitcnt lgkmcnt(0)
    s_barrier
    v_mfma_f32_16x16x32_bf16 v[44:47], v[96:99], v[28:31], v[44:47]
    ds_read_b64_tr_b16 v[88:89], v120 offset:32768
    v_mfma_f32_16x16x32_bf16 v[48:51], v[100:103], v[28:31], v[48:51]
    ds_read_b64_tr_b16 v[90:91], v120 offset:33792
    v_mfma_f32_16x16x32_bf16 v[52:55], v[96:99], v[32:35], v[52:55]
    ds_read_b128 v[12:15], v112 offset:32768
    s_add_u32 m0, s58, 65536
    s_bfe_u32 s56, s59, 196616
    s_xor_b32 s56, s56, 4
    s_mul_i32 s57, s56, 229376
    s_lshl_b32 s56, s56, 7
    buffer_load_dwordx4 v4, s[4:7], s56 offen offset:0 lds
    v_mfma_f32_16x16x32_bf16 v[56:59], v[100:103], v[32:35], v[56:59]
    ds_read_b64_tr_b16 v[92:93], v121 offset:32768
    v_mfma_f32_16x16x32_bf16 v[60:63], v[96:99], v[36:39], v[60:63]
    ds_read_b64_tr_b16 v[94:95], v121 offset:33792
    v_mfma_f32_16x16x32_bf16 v[64:67], v[100:103], v[36:39], v[64:67]
    ds_read_b128 v[16:19], v113 offset:32768
    v_mfma_f32_16x16x32_bf16 v[68:71], v[96:99], v[40:43], v[68:71]
    ds_read_b128 v[20:23], v114 offset:32768
    v_mfma_f32_16x16x32_bf16 v[72:75], v[100:103], v[40:43], v[72:75]
    ds_read_b128 v[24:27], v115 offset:32768
    v_mfma_f32_16x16x32_bf16 v[152:155], v[28:31], v[28:31], v[152:155]
    ds_read_b128 v[104:107], v8 offset:6144
    buffer_load_dwordx4 v5, s[4:7], s56 offen offset:1024 lds
    v_mfma_f32_16x16x32_bf16 v[148:151], v[128:131], v[28:31], v[148:151]
    v_mfma_f32_16x16x32_bf16 v[76:79], v[108:111], v[28:31], v[76:79]
    s_waitcnt lgkmcnt(0)
    v_mfma_f32_16x16x32_bf16 v[44:47], v[88:91], v[12:15], v[44:47]
    ds_read_b64_tr_b16 v[96:97], v122 offset:32768
    v_mfma_f32_16x16x32_bf16 v[48:51], v[92:95], v[12:15], v[48:51]
    ds_read_b64_tr_b16 v[98:99], v122 offset:33792
    v_mfma_f32_16x16x32_bf16 v[52:55], v[88:91], v[16:19], v[52:55]
    ds_read_b128 v[28:31], v116 offset:32768
    buffer_load_dwordx4 v6, s[8:11], s57 offen offset:2048 lds
    v_mfma_f32_16x16x32_bf16 v[56:59], v[92:95], v[16:19], v[56:59]
    ds_read_b64_tr_b16 v[100:101], v123 offset:32768
    v_mfma_f32_16x16x32_bf16 v[60:63], v[88:91], v[20:23], v[60:63]
    ds_read_b64_tr_b16 v[102:103], v123 offset:33792
    v_mfma_f32_16x16x32_bf16 v[64:67], v[92:95], v[20:23], v[64:67]
    ds_read_b128 v[32:35], v117 offset:32768
    v_mfma_f32_16x16x32_bf16 v[68:71], v[88:91], v[24:27], v[68:71]
    ds_read_b128 v[36:39], v118 offset:32768
    buffer_load_dwordx4 v7, s[8:11], s57 offen offset:3072 lds
    v_mfma_f32_16x16x32_bf16 v[72:75], v[92:95], v[24:27], v[72:75]
    ds_read_b128 v[40:43], v119 offset:32768
    v_mfma_f32_16x16x32_bf16 v[152:155], v[12:15], v[12:15], v[152:155]
    ds_read_b128 v[108:111], v9 offset:6144
    v_mfma_f32_16x16x32_bf16 v[148:151], v[128:131], v[12:15], v[148:151]
    v_mfma_f32_16x16x32_bf16 v[76:79], v[104:107], v[12:15], v[76:79]
    v_mov_b32 v236, -1
    v_mov_b32 v237, -1
    v_mov_b32 v238, -1
    v_mov_b32 v239, -1
    s_mul_i32 s52, s2, 8448
    s_add_u32 s52, s52, 2359296
    s_lshl_b32 s53, s2, 13
    s_add_u32 s53, s53, 16777216
    s_cmp_eq_u32 s48, 0
    s_cselect_b32 s52, s52, s53
    v_lshl_add_u32 v240, v0, 4, s52
    v_lshl_add_u32 v240, s49, 11, v240
    buffer_store_dwordx4 v[236:239], v240, s[12:15], 0 offen offset:0 sc1
    v_mfma_f32_16x16x32_bf16 v[80:83], v[88:91], v[128:131], v[80:83]
    v_mfma_f32_16x16x32_bf16 v[84:87], v[92:95], v[128:131], v[84:87]
    s_waitcnt vmcnt(11)
    s_waitcnt vmcnt(9)
    s_waitcnt lgkmcnt(0)
    s_barrier
    v_xor_b32 v112, 0x10000, v112
    v_xor_b32 v113, 0x10000, v113
    v_xor_b32 v114, 0x10000, v114
    v_xor_b32 v115, 0x10000, v115
    v_xor_b32 v120, 0x10000, v120
    v_xor_b32 v121, 0x10000, v121
    v_mfma_f32_16x16x32_bf16 v[44:47], v[96:99], v[28:31], v[44:47]
    ds_read_b64_tr_b16 v[88:89], v120 offset:0
    v_mfma_f32_16x16x32_bf16 v[48:51], v[100:103], v[28:31], v[48:51]
    ds_read_b64_tr_b16 v[90:91], v120 offset:1024
    v_mfma_f32_16x16x32_bf16 v[52:55], v[96:99], v[32:35], v[52:55]
    ds_read_b128 v[12:15], v112 offset:0
    s_add_u32 m0, s58, 98304
    s_bfe_u32 s56, s59, 196620
    s_xor_b32 s56, s56, 4
    s_mul_i32 s57, s56, 229376
    s_lshl_b32 s56, s56, 7
    buffer_load_dwordx4 v4, s[4:7], s56 offen offset:0 lds
    v_mfma_f32_16x16x32_bf16 v[56:59], v[100:103], v[32:35], v[56:59]
    ds_read_b64_tr_b16 v[92:93], v121 offset:0
    v_mfma_f32_16x16x32_bf16 v[60:63], v[96:99], v[36:39], v[60:63]
    ds_read_b64_tr_b16 v[94:95], v121 offset:1024
    v_mfma_f32_16x16x32_bf16 v[64:67], v[100:103], v[36:39], v[64:67]
    ds_read_b128 v[16:19], v113 offset:0
    v_mfma_f32_16x16x32_bf16 v[68:71], v[96:99], v[40:43], v[68:71]
    ds_read_b128 v[20:23], v114 offset:0
    v_mfma_f32_16x16x32_bf16 v[72:75], v[100:103], v[40:43], v[72:75]
    ds_read_b128 v[24:27], v115 offset:0
    v_mfma_f32_16x16x32_bf16 v[152:155], v[28:31], v[28:31], v[152:155]
    ds_read_b128 v[104:107], v8 offset:0
    buffer_load_dwordx4 v5, s[4:7], s56 offen offset:1024 lds
    v_mfma_f32_16x16x32_bf16 v[148:151], v[128:131], v[28:31], v[148:151]
    ds_read_u16 v140, v244 offset:0
    v_mfma_f32_16x16x32_bf16 v[76:79], v[108:111], v[28:31], v[76:79]
    ds_read_u16 v144, v244 offset:4096
    ds_read_u16 v141, v244 offset:1024
    ds_read_u16 v145, v244 offset:5120
    ds_read_u16 v142, v244 offset:2048
    ds_read_u16 v146, v244 offset:6144
    ds_read_u16 v143, v244 offset:3072
    ds_read_u16 v147, v244 offset:7168
    v_xor_b32 v116, 0x10000, v116
    v_xor_b32 v117, 0x10000, v117
    v_xor_b32 v118, 0x10000, v118
    v_xor_b32 v119, 0x10000, v119
    v_xor_b32 v122, 0x10000, v122
    v_xor_b32 v123, 0x10000, v123
    s_waitcnt lgkmcnt(0)
    v_xor_b32 v76, 0x80000000, v76
    v_xor_b32 v77, 0x80000000, v77
    v_mfma_f32_16x16x32_bf16 v[44:47], v[88:91], v[12:15], v[44:47]
    ds_read_b64_tr_b16 v[96:97], v122 offset:0
    v_mfma_f32_16x16x32_bf16 v[48:51], v[92:95], v[12:15], v[48:51]
    ds_read_b64_tr_b16 v[98:99], v122 offset:1024
    v_mfma_f32_16x16x32_bf16 v[52:55], v[88:91], v[16:19], v[52:55]
    ds_read_b128 v[28:31], v116 offset:0
    buffer_load_dwordx4 v6, s[8:11], s57 offen offset:2048 lds
    v_mfma_f32_16x16x32_bf16 v[56:59], v[92:95], v[16:19], v[56:59]
    ds_read_b64_tr_b16 v[100:101], v123 offset:0
    v_mfma_f32_16x16x32_bf16 v[60:63], v[88:91], v[20:23], v[60:63]
    ds_read_b64_tr_b16 v[102:103], v123 offset:1024
    v_mfma_f32_16x16x32_bf16 v[64:67], v[92:95], v[20:23], v[64:67]
    ds_read_b128 v[32:35], v117 offset:0
    v_mfma_f32_16x16x32_bf16 v[68:71], v[88:91], v[24:27], v[68:71]
    ds_read_b128 v[36:39], v118 offset:0
    buffer_load_dwordx4 v7, s[8:11], s57 offen offset:3072 lds
    v_mfma_f32_16x16x32_bf16 v[72:75], v[92:95], v[24:27], v[72:75]
    ds_read_b128 v[40:43], v119 offset:0
    v_mfma_f32_16x16x32_bf16 v[152:155], v[12:15], v[12:15], v[152:155]
    ds_read_b128 v[108:111], v9 offset:0
    v_mfma_f32_16x16x32_bf16 v[148:151], v[128:131], v[12:15], v[148:151]
    v_mfma_f32_16x16x32_bf16 v[76:79], v[104:107], v[12:15], v[76:79]
    v_lshl_or_b32 v140, v144, 16, v140
    v_lshl_or_b32 v141, v145, 16, v141
    v_lshl_or_b32 v142, v146, 16, v142
    v_lshl_or_b32 v143, v147, 16, v143
    buffer_store_dwordx4 v[140:143], v245, s[12:15], 0 offen sc1
    v_mfma_f32_16x16x32_bf16 v[80:83], v[88:91], v[128:131], v[80:83]
    v_mfma_f32_16x16x32_bf16 v[84:87], v[92:95], v[128:131], v[84:87]
    s_waitcnt vmcnt(10)
    s_waitcnt lgkmcnt(0)
    s_barrier
    v_mfma_f32_16x16x32_bf16 v[44:47], v[96:99], v[28:31], v[44:47]
    ds_read_b64_tr_b16 v[88:89], v120 offset:32768
    v_mfma_f32_16x16x32_bf16 v[48:51], v[100:103], v[28:31], v[48:51]
    ds_read_b64_tr_b16 v[90:91], v120 offset:33792
    v_mfma_f32_16x16x32_bf16 v[52:55], v[96:99], v[32:35], v[52:55]
    ds_read_b128 v[12:15], v112 offset:32768
    s_add_u32 m0, s58, 0
    s_lshl3_add_u32 s63, s82, 0
    buffer_load_dwordx4 v252, s[24:27], s63 offen offset:0 lds
    v_mfma_f32_16x16x32_bf16 v[56:59], v[100:103], v[32:35], v[56:59]
    ds_read_b64_tr_b16 v[92:93], v121 offset:32768
    v_mfma_f32_16x16x32_bf16 v[60:63], v[96:99], v[36:39], v[60:63]
    ds_read_b64_tr_b16 v[94:95], v121 offset:33792
    v_mfma_f32_16x16x32_bf16 v[64:67], v[100:103], v[36:39], v[64:67]
    ds_read_b128 v[16:19], v113 offset:32768
    v_mfma_f32_16x16x32_bf16 v[68:71], v[96:99], v[40:43], v[68:71]
    ds_read_b128 v[20:23], v114 offset:32768
    v_mfma_f32_16x16x32_bf16 v[72:75], v[100:103], v[40:43], v[72:75]
    ds_read_b128 v[24:27], v115 offset:32768
    v_mfma_f32_16x16x32_bf16 v[152:155], v[28:31], v[28:31], v[152:155]
    ds_read_b128 v[104:107], v8 offset:2048
    s_lshl3_add_u32 s63, s82, 7168
    buffer_load_dwordx4 v252, s[24:27], s63 offen offset:1024 lds
    v_mfma_f32_16x16x32_bf16 v[148:151], v[128:131], v[28:31], v[148:151]
    v_mfma_f32_16x16x32_bf16 v[76:79], v[108:111], v[28:31], v[76:79]
    s_waitcnt lgkmcnt(0)
    v_mfma_f32_16x16x32_bf16 v[44:47], v[88:91], v[12:15], v[44:47]
    ds_read_b64_tr_b16 v[96:97], v122 offset:32768
    v_mfma_f32_16x16x32_bf16 v[48:51], v[92:95], v[12:15], v[48:51]
    ds_read_b64_tr_b16 v[98:99], v122 offset:33792
    v_mfma_f32_16x16x32_bf16 v[52:55], v[88:91], v[16:19], v[52:55]
    ds_read_b128 v[28:31], v116 offset:32768
    v_mfma_f32_16x16x32_bf16 v[56:59], v[92:95], v[16:19], v[56:59]
    ds_read_b64_tr_b16 v[100:101], v123 offset:32768
    s_add_u32 m0, s58, 0
    s_lshl3_add_u32 s63, s82, 14336
    buffer_load_dwordx4 v252, s[24:27], s63 offen offset:2048 lds
    v_mfma_f32_16x16x32_bf16 v[60:63], v[88:91], v[20:23], v[60:63]
    ds_read_b64_tr_b16 v[102:103], v123 offset:33792
    v_mfma_f32_16x16x32_bf16 v[64:67], v[92:95], v[20:23], v[64:67]
    ds_read_b128 v[32:35], v117 offset:32768
    v_mfma_f32_16x16x32_bf16 v[68:71], v[88:91], v[24:27], v[68:71]
    ds_read_b128 v[36:39], v118 offset:32768
    v_mfma_f32_16x16x32_bf16 v[72:75], v[92:95], v[24:27], v[72:75]
    ds_read_b128 v[40:43], v119 offset:32768
    v_mfma_f32_16x16x32_bf16 v[152:155], v[12:15], v[12:15], v[152:155]
    ds_read_b128 v[108:111], v9 offset:2048
    v_mfma_f32_16x16x32_bf16 v[148:151], v[128:131], v[12:15], v[148:151]
    s_lshl3_add_u32 s63, s82, 21504
    buffer_load_dwordx4 v252, s[24:27], s63 offen offset:3072 lds
    v_mfma_f32_16x16x32_bf16 v[76:79], v[104:107], v[12:15], v[76:79]
    v_mfma_f32_16x16x32_bf16 v[80:83], v[88:91], v[128:131], v[80:83]
    v_mfma_f32_16x16x32_bf16 v[84:87], v[92:95], v[128:131], v[84:87]
    s_waitcnt vmcnt(10)
    s_waitcnt lgkmcnt(0)
    s_barrier
    v_xor_b32 v112, 0x10000, v112
    v_xor_b32 v113, 0x10000, v113
    v_xor_b32 v114, 0x10000, v114
    v_xor_b32 v115, 0x10000, v115
    v_xor_b32 v120, 0x10000, v120
    v_xor_b32 v121, 0x10000, v121
    v_mfma_f32_16x16x32_bf16 v[44:47], v[96:99], v[28:31], v[44:47]
    ds_read_b64_tr_b16 v[88:89], v120 offset:0
    v_mfma_f32_16x16x32_bf16 v[48:51], v[100:103], v[28:31], v[48:51]
    ds_read_b64_tr_b16 v[90:91], v120 offset:1024
    v_mfma_f32_16x16x32_bf16 v[52:55], v[96:99], v[32:35], v[52:55]
    ds_read_b128 v[12:15], v112 offset:0
    s_add_u32 m0, s58, 32768
    s_lshl3_add_u32 s63, s83, 0
    buffer_load_dwordx4 v252, s[24:27], s63 offen offset:0 lds
    v_mfma_f32_16x16x32_bf16 v[56:59], v[100:103], v[32:35], v[56:59]
    ds_read_b64_tr_b16 v[92:93], v121 offset:0
    v_mfma_f32_16x16x32_bf16 v[60:63], v[96:99], v[36:39], v[60:63]
    ds_read_b64_tr_b16 v[94:95], v121 offset:1024
    v_mfma_f32_16x16x32_bf16 v[64:67], v[100:103], v[36:39], v[64:67]
    ds_read_b128 v[16:19], v113 offset:0
    v_mfma_f32_16x16x32_bf16 v[68:71], v[96:99], v[40:43], v[68:71]
    ds_read_b128 v[20:23], v114 offset:0
    v_mfma_f32_16x16x32_bf16 v[72:75], v[100:103], v[40:43], v[72:75]
    ds_read_b128 v[24:27], v115 offset:0
    v_mfma_f32_16x16x32_bf16 v[152:155], v[28:31], v[28:31], v[152:155]
    ds_read_b128 v[104:107], v8 offset:4096
    s_lshl3_add_u32 s63, s83, 7168
    buffer_load_dwordx4 v252, s[24:27], s63 offen offset:1024 lds
    v_mfma_f32_16x16x32_bf16 v[148:151], v[128:131], v[28:31], v[148:151]
    v_mfma_f32_16x16x32_bf16 v[76:79], v[108:111], v[28:31], v[76:79]
    v_xor_b32 v116, 0x10000, v116
    v_xor_b32 v117, 0x10000, v117
    v_xor_b32 v118, 0x10000, v118
    v_xor_b32 v119, 0x10000, v119
    v_xor_b32 v122, 0x10000, v122
    v_xor_b32 v123, 0x10000, v123
    s_waitcnt lgkmcnt(0)
    v_mfma_f32_16x16x32_bf16 v[44:47], v[88:91], v[12:15], v[44:47]
    ds_read_b64_tr_b16 v[96:97], v122 offset:0
    v_mfma_f32_16x16x32_bf16 v[48:51], v[92:95], v[12:15], v[48:51]
    ds_read_b64_tr_b16 v[98:99], v122 offset:1024
    v_mfma_f32_16x16x32_bf16 v[52:55], v[88:91], v[16:19], v[52:55]
    ds_read_b128 v[28:31], v116 offset:0
    v_mfma_f32_16x16x32_bf16 v[56:59], v[92:95], v[16:19], v[56:59]
    ds_read_b64_tr_b16 v[100:101], v123 offset:0
    s_add_u32 m0, s58, 32768
    s_lshl3_add_u32 s63, s83, 14336
    buffer_load_dwordx4 v252, s[24:27], s63 offen offset:2048 lds
    v_mfma_f32_16x16x32_bf16 v[60:63], v[88:91], v[20:23], v[60:63]
    ds_read_b64_tr_b16 v[102:103], v123 offset:1024
    v_mfma_f32_16x16x32_bf16 v[64:67], v[92:95], v[20:23], v[64:67]
    ds_read_b128 v[32:35], v117 offset:0
    v_mfma_f32_16x16x32_bf16 v[68:71], v[88:91], v[24:27], v[68:71]
    ds_read_b128 v[36:39], v118 offset:0
    v_mfma_f32_16x16x32_bf16 v[72:75], v[92:95], v[24:27], v[72:75]
    ds_read_b128 v[40:43], v119 offset:0
    v_mfma_f32_16x16x32_bf16 v[152:155], v[12:15], v[12:15], v[152:155]
    ds_read_b128 v[108:111], v9 offset:4096
    v_mfma_f32_16x16x32_bf16 v[148:151], v[128:131], v[12:15], v[148:151]
    s_lshl3_add_u32 s63, s83, 21504
    buffer_load_dwordx4 v252, s[24:27], s63 offen offset:3072 lds
    v_mfma_f32_16x16x32_bf16 v[76:79], v[104:107], v[12:15], v[76:79]
    v_mfma_f32_16x16x32_bf16 v[80:83], v[88:91], v[128:131], v[80:83]
    v_mfma_f32_16x16x32_bf16 v[84:87], v[92:95], v[128:131], v[84:87]
    s_waitcnt vmcnt(9)
    s_waitcnt lgkmcnt(0)
    s_barrier
    v_mfma_f32_16x16x32_bf16 v[44:47], v[96:99], v[28:31], v[44:47]
    ds_read_b64_tr_b16 v[88:89], v120 offset:32768
    s_lshl_b32 s54, s44, 7
    v_mfma_f32_16x16x32_bf16 v[48:51], v[100:103], v[28:31], v[48:51]
    ds_read_b64_tr_b16 v[90:91], v120 offset:33792
    s_add_u32 s54, s54, 151552
    v_mfma_f32_16x16x32_bf16 v[52:55], v[96:99], v[32:35], v[52:55]
    ds_read_b128 v[12:15], v112 offset:32768
    s_add_u32 m0, s58, 65536
    s_lshl3_add_u32 s63, s84, 0
    buffer_load_dwordx4 v252, s[24:27], s63 offen offset:0 lds
    v_lshl_add_u32 v137, v2, 4, s54
    v_mfma_f32_16x16x32_bf16 v[56:59], v[100:103], v[32:35], v[56:59]
    ds_read_b64_tr_b16 v[92:93], v121 offset:32768
    v_and_b32 v139, 31, v0
    v_mfma_f32_16x16x32_bf16 v[60:63], v[96:99], v[36:39], v[60:63]
    ds_read_b64_tr_b16 v[94:95], v121 offset:33792
    v_lshlrev_b32 v139, 4, v139
    v_mfma_f32_16x16x32_bf16 v[64:67], v[100:103], v[36:39], v[64:67]
    ds_read_b128 v[16:19], v113 offset:32768
    v_lshl_add_u32 v136, v3, 9, v139
    v_mfma_f32_16x16x32_bf16 v[68:71], v[96:99], v[40:43], v[68:71]
    ds_read_b128 v[20:23], v114 offset:32768
    v_add_u32 v136, 147456, v136
    v_mfma_f32_16x16x32_bf16 v[72:75], v[100:103], v[40:43], v[72:75]
    ds_read_b128 v[24:27], v115 offset:32768
    v_mfma_f32_16x16x32_bf16 v[152:155], v[28:31], v[28:31], v[152:155]
    ds_read_b128 v[104:107], v8 offset:6144
    s_lshl3_add_u32 s63, s84, 7168
    buffer_load_dwordx4 v252, s[24:27], s63 offen offset:1024 lds
    v_mfma_f32_16x16x32_bf16 v[148:151], v[128:131], v[28:31], v[148:151]
    ds_read_b128 v[140:143], v116 offset:32768
    v_mfma_f32_16x16x32_bf16 v[76:79], v[108:111], v[28:31], v[76:79]
    ds_read_b128 v[144:147], v9 offset:6144
    s_waitcnt lgkmcnt(0)
    v_mfma_f32_16x16x32_bf16 v[152:155], v[12:15], v[12:15], v[152:155]
    ds_read_b64_tr_b16 v[96:97], v122 offset:32768
    ds_read_b64_tr_b16 v[98:99], v122 offset:33792
    v_mfma_f32_16x16x32_bf16 v[152:155], v[140:143], v[140:143], v[152:155]
    ds_read_b64_tr_b16 v[100:101], v123 offset:32768
    ds_read_b64_tr_b16 v[102:103], v123 offset:33792
    s_add_u32 m0, s58, 65536
    s_lshl3_add_u32 s63, s84, 14336
    buffer_load_dwordx4 v252, s[24:27], s63 offen offset:2048 lds
    v_mfma_f32_16x16x32_bf16 v[148:151], v[128:131], v[12:15], v[148:151]
    ds_read_b128 v[32:35], v117 offset:32768
    ds_read_b128 v[36:39], v118 offset:32768
    v_mfma_f32_16x16x32_bf16 v[148:151], v[128:131], v[140:143], v[148:151]
    ds_read_b128 v[40:43], v119 offset:32768
    v_mfma_f32_16x16x32_bf16 v[76:79], v[104:107], v[12:15], v[76:79]
    v_mfma_f32_16x16x32_bf16 v[76:79], v[144:147], v[140:143], v[76:79]
    s_lshl3_add_u32 s63, s84, 21504
    buffer_load_dwordx4 v252, s[24:27], s63 offen offset:3072 lds
    v_mfma_f32_16x16x32_bf16 v[80:83], v[88:91], v[128:131], v[80:83]
    v_mfma_f32_16x16x32_bf16 v[84:87], v[92:95], v[128:131], v[84:87]
    v_mfma_f32_16x16x32_bf16 v[44:47], v[88:91], v[12:15], v[44:47]
    buffer_store_dwordx4 v[236:239], v240, s[12:15], 0 offen offset:1024 sc1
    v_mfma_f32_16x16x32_bf16 v[48:51], v[92:95], v[12:15], v[48:51]
    v_mfma_f32_16x16x32_bf16 v[52:55], v[88:91], v[16:19], v[52:55]
    v_cndmask_b32 v152, v152, v153, s[74:75]
    v_cndmask_b32 v152, v152, v154, s[76:77]
    v_cndmask_b32 v152, v152, v155, s[78:79]
    ds_bpermute_b32 v152, v247, v152
    v_mfma_f32_16x16x32_bf16 v[56:59], v[92:95], v[16:19], v[56:59]
    v_mul_f32 v148, 0x3b000000, v148
    ds_write_b128 v137, v[80:83]
    ds_write_b128 v137, v[84:87] offset:64
    v_xor_b32 v121, 512, v248
    v_mfma_f32_16x16x32_bf16 v[60:63], v[88:91], v[20:23], v[60:63]
    v_xor_b32 v122, 1024, v248
    v_xor_b32 v123, 1536, v248
    v_mfma_f32_16x16x32_bf16 v[64:67], v[92:95], v[20:23], v[64:67]
    s_waitcnt lgkmcnt(2)
    v_mfma_f32_16x16x32_bf16 v[68:71], v[88:91], v[24:27], v[68:71]
    v_mul_f32 v152, 0x3b000000, v152
    v_fma_f32 v152, -v148, v148, v152
    v_max_f32 v152, 0, v152
    v_add_f32 v135, 0x3727c5ac, v152
    v_rsq_f32 v133, v135
    v_mfma_f32_16x16x32_bf16 v[72:75], v[92:95], v[24:27], v[72:75]
    v_fmamk_f32 v135, v135, 0x3727c5ac, v152
    v_rsq_f32 v132, v135
    v_mul_f32 v76, -v76, v133
    v_mul_f32 v77, -v77, v133
    v_mul_f32 v78, v78, v133
    v_mfma_f32_16x16x32_bf16 v[44:47], v[96:99], v[140:143], v[44:47]
    v_mul_f32 v79, v79, v133
    v_mul_f32 v134, -v132, v148
    v_cvt_pk_bf16_f32 v76, v76, v77
    v_cvt_pk_bf16_f32 v77, v78, v79
    v_mov_b32 v133, v132
    v_mfma_f32_16x16x32_bf16 v[48:51], v[100:103], v[140:143], v[48:51]
    v_mov_b32 v135, v134
    ds_write_b128 v248, v[132:135]
    ds_write_b32 v249, v76
    ds_write_b32 v249, v77 offset:512
    s_waitcnt lgkmcnt(0)
    s_barrier
    v_xor_b32 v137, 512, v137
    v_mfma_f32_16x16x32_bf16 v[52:55], v[96:99], v[32:35], v[52:55]
    ds_read_b128 v[76:79], v136
    ds_read_b128 v[112:115], v137 offset:0
    ds_read_b128 v[116:119], v137 offset:64
    v_mfma_f32_16x16x32_bf16 v[56:59], v[100:103], v[32:35], v[56:59]
    ds_read_b128 v[140:143], v248
    ds_read_b128 v[144:147], v121
    ds_read_b128 v[148:151], v122
    v_mfma_f32_16x16x32_bf16 v[60:63], v[96:99], v[36:39], v[60:63]
    ds_read_b128 v[152:155], v123
    v_mfma_f32_16x16x32_bf16 v[64:67], v[100:103], v[36:39], v[64:67]
    v_mfma_f32_16x16x32_bf16 v[68:71], v[96:99], v[40:43], v[68:71]
    v_mfma_f32_16x16x32_bf16 v[72:75], v[100:103], v[40:43], v[72:75]
    s_waitcnt lgkmcnt(6)
    s_mov_b32 exec_hi, 0
    buffer_store_dwordx4 v[76:79], v139, s[12:15], s72 offen sc1
    s_mov_b64 exec, -1
    s_waitcnt lgkmcnt(0)
    s_setprio 2
    v_lshlrev_b32 v104, 16, v124
    v_and_b32 v105, 0xffff0000, v124
    v_lshlrev_b32 v106, 16, v125
    v_and_b32 v107, 0xffff0000, v125
    v_lshlrev_b32 v108, 16, v126
    v_and_b32 v109, 0xffff0000, v126
    v_lshlrev_b32 v110, 16, v127
    v_and_b32 v111, 0xffff0000, v127
    s_mov_b32 s68, 0xc0135761
    s_mov_b32 s69, 0xc0135761
    v_mov_b32 v128, 0xbdd2d3e8
    v_mov_b32 v129, 0xbdd2d3e8
    v_mov_b32 v130, 1.0
    v_mov_b32 v131, 1.0
    s_mul_i32 s52, s66, 896
    s_lshl2_add_u32 s53, s51, s49
    s_lshl_b32 s53, s53, 12
    s_add_u32 s52, s52, s53
    s_add_u32 s52, s52, 7077888
    v_lshlrev_b32 v138, 4, v0
    v_lshl_add_u32 v138, s49, 10, v138
    v_pk_add_f32 v[80:81], v[80:81], v[112:113]
    v_pk_add_f32 v[82:83], v[82:83], v[114:115]
    v_pk_add_f32 v[84:85], v[84:85], v[116:117]
    v_pk_add_f32 v[86:87], v[86:87], v[118:119]
    s_cmp_eq_u32 s48, 1
    s_cbranch_scc0 L_np_4
    s_waitcnt vmcnt(14)
    s_waitcnt vmcnt(0)
    s_mov_b64 exec, 1023
    buffer_store_dword v255, v250, s[12:15], 0 offen sc1
    s_mov_b64 exec, -1
L_np_4:
    s_cmp_eq_u32 s48, 0
    s_cbranch_scc0 L_nd3_5
    s_add_u32 m0, s58, 98304
    s_lshl3_add_u32 s63, s85, 0
    buffer_load_dwordx4 v252, s[24:27], s63 offen offset:0 lds
    s_lshl3_add_u32 s63, s85, 7168
    buffer_load_dwordx4 v252, s[24:27], s63 offen offset:1024 lds
    s_add_u32 m0, s58, 98304
    s_lshl3_add_u32 s63, s85, 14336
    buffer_load_dwordx4 v252, s[24:27], s63 offen offset:2048 lds
    s_lshl3_add_u32 s63, s85, 21504
    buffer_load_dwordx4 v252, s[24:27], s63 offen offset:3072 lds
L_nd3_5:
    v_pk_fma_f32 v[88:89], v[142:143], v[80:81], v[104:105]
    v_pk_fma_f32 v[90:91], v[142:143], v[82:83], v[106:107]
    v_pk_fma_f32 v[92:93], v[142:143], v[84:85], v[108:109]
    v_pk_fma_f32 v[94:95], v[142:143], v[86:87], v[110:111]
    v_pk_fma_f32 v[44:45], v[44:45], v[140:141], v[88:89]
    v_pk_fma_f32 v[46:47], v[46:47], v[140:141], v[90:91]
    v_pk_fma_f32 v[48:49], v[48:49], v[140:141], v[92:93]
    v_pk_fma_f32 v[50:51], v[50:51], v[140:141], v[94:95]
    v_pk_mul_f32 v[88:89], v[44:45], v[44:45]
    v_pk_mul_f32 v[90:91], v[46:47], v[46:47]
    v_pk_mul_f32 v[92:93], v[48:49], v[48:49]
    v_pk_mul_f32 v[94:95], v[50:51], v[50:51]
    v_pk_fma_f32 v[88:89], v[88:89], v[128:129], s[68:69]
    v_pk_fma_f32 v[90:91], v[90:91], v[128:129], s[68:69]
    v_pk_fma_f32 v[92:93], v[92:93], v[128:129], s[68:69]
    v_pk_fma_f32 v[94:95], v[94:95], v[128:129], s[68:69]
    v_pk_mul_f32 v[88:89], v[88:89], v[44:45]
    v_pk_mul_f32 v[90:91], v[90:91], v[46:47]
    v_pk_mul_f32 v[92:93], v[92:93], v[48:49]
    v_pk_mul_f32 v[94:95], v[94:95], v[50:51]
    v_exp_f32 v88, v88
    v_exp_f32 v89, v89
    v_exp_f32 v90, v90
    v_exp_f32 v91, v91
    v_exp_f32 v92, v92
    v_exp_f32 v93, v93
    v_exp_f32 v94, v94
    v_exp_f32 v95, v95
    v_add_f32 v88, 1.0, v88
    v_add_f32 v89, 1.0, v89
    v_add_f32 v90, 1.0, v90
    v_add_f32 v91, 1.0, v91
    v_add_f32 v92, 1.0, v92
    v_add_f32 v93, 1.0, v93
    v_add_f32 v94, 1.0, v94
    v_add_f32 v95, 1.0, v95
    v_rcp_f32 v88, v88
    v_rcp_f32 v89, v89
    v_rcp_f32 v90, v90
    v_rcp_f32 v91, v91
    v_rcp_f32 v92, v92
    v_rcp_f32 v93, v93
    v_rcp_f32 v94, v94
    v_rcp_f32 v95, v95
    v_pk_mul_f32 v[44:45], v[44:45], v[88:89]
    v_pk_mul_f32 v[46:47], v[46:47], v[90:91]
    v_pk_mul_f32 v[48:49], v[48:49], v[92:93]
    v_pk_mul_f32 v[50:51], v[50:51], v[94:95]
    v_cvt_pk_bf16_f32 v28, v44, v45
    v_cvt_pk_bf16_f32 v29, v46, v47
    v_cvt_pk_bf16_f32 v30, v48, v49
    v_cvt_pk_bf16_f32 v31, v50, v51
    v_pk_fma_f32 v[88:89], v[146:147], v[80:81], v[104:105]
    v_pk_fma_f32 v[90:91], v[146:147], v[82:83], v[106:107]
    v_pk_fma_f32 v[92:93], v[146:147], v[84:85], v[108:109]
    v_pk_fma_f32 v[94:95], v[146:147], v[86:87], v[110:111]
    v_pk_fma_f32 v[52:53], v[52:53], v[144:145], v[88:89]
    v_pk_fma_f32 v[54:55], v[54:55], v[144:145], v[90:91]
    v_pk_fma_f32 v[56:57], v[56:57], v[144:145], v[92:93]
    v_pk_fma_f32 v[58:59], v[58:59], v[144:145], v[94:95]
    v_pk_mul_f32 v[88:89], v[52:53], v[52:53]
    v_pk_mul_f32 v[90:91], v[54:55], v[54:55]
    v_pk_mul_f32 v[92:93], v[56:57], v[56:57]
    v_pk_mul_f32 v[94:95], v[58:59], v[58:59]
    v_pk_fma_f32 v[88:89], v[88:89], v[128:129], s[68:69]
    v_pk_fma_f32 v[90:91], v[90:91], v[128:129], s[68:69]
    v_pk_fma_f32 v[92:93], v[92:93], v[128:129], s[68:69]
    v_pk_fma_f32 v[94:95], v[94:95], v[128:129], s[68:69]
    v_pk_mul_f32 v[88:89], v[88:89], v[52:53]
    v_pk_mul_f32 v[90:91], v[90:91], v[54:55]
    v_pk_mul_f32 v[92:93], v[92:93], v[56:57]
    v_pk_mul_f32 v[94:95], v[94:95], v[58:59]
    v_exp_f32 v88, v88
    v_exp_f32 v89, v89
    v_exp_f32 v90, v90
    v_exp_f32 v91, v91
    v_exp_f32 v92, v92
    v_exp_f32 v93, v93
    v_exp_f32 v94, v94
    v_exp_f32 v95, v95
    v_add_f32 v88, 1.0, v88
    v_add_f32 v89, 1.0, v89
    v_add_f32 v90, 1.0, v90
    v_add_f32 v91, 1.0, v91
    v_add_f32 v92, 1.0, v92
    v_add_f32 v93, 1.0, v93
    v_add_f32 v94, 1.0, v94
    v_add_f32 v95, 1.0, v95
    v_rcp_f32 v88, v88
    v_rcp_f32 v89, v89
    v_rcp_f32 v90, v90
    v_rcp_f32 v91, v91
    v_rcp_f32 v92, v92
    v_rcp_f32 v93, v93
    v_rcp_f32 v94, v94
    v_rcp_f32 v95, v95
    v_pk_mul_f32 v[52:53], v[52:53], v[88:89]
    v_pk_mul_f32 v[54:55], v[54:55], v[90:91]
    v_pk_mul_f32 v[56:57], v[56:57], v[92:93]
    v_pk_mul_f32 v[58:59], v[58:59], v[94:95]
    v_cvt_pk_bf16_f32 v32, v52, v53
    v_cvt_pk_bf16_f32 v33, v54, v55
    v_cvt_pk_bf16_f32 v34, v56, v57
    v_cvt_pk_bf16_f32 v35, v58, v59
    s_cmp_eq_u32 s48, 0
    s_cbranch_scc0 L_np_6
    s_waitcnt vmcnt(18)
    s_waitcnt vmcnt(4)
    s_mov_b64 exec, 1023
    buffer_store_dword v255, v250, s[12:15], 0 offen sc1
    s_mov_b64 exec, -1
L_np_6:
    v_xor_b32 v139, 0, v138
    buffer_store_dwordx4 v[28:31], v139, s[12:15], s52 offen sc1
    v_xor_b32 v139, 1024, v138
    buffer_store_dwordx4 v[32:35], v139, s[12:15], s52 offen sc1
    v_pk_fma_f32 v[88:89], v[150:151], v[80:81], v[104:105]
    v_pk_fma_f32 v[90:91], v[150:151], v[82:83], v[106:107]
    v_pk_fma_f32 v[92:93], v[150:151], v[84:85], v[108:109]
    v_pk_fma_f32 v[94:95], v[150:151], v[86:87], v[110:111]
    v_pk_fma_f32 v[60:61], v[60:61], v[148:149], v[88:89]
    v_pk_fma_f32 v[62:63], v[62:63], v[148:149], v[90:91]
    v_pk_fma_f32 v[64:65], v[64:65], v[148:149], v[92:93]
    v_pk_fma_f32 v[66:67], v[66:67], v[148:149], v[94:95]
    v_pk_mul_f32 v[88:89], v[60:61], v[60:61]
    v_pk_mul_f32 v[90:91], v[62:63], v[62:63]
    v_pk_mul_f32 v[92:93], v[64:65], v[64:65]
    v_pk_mul_f32 v[94:95], v[66:67], v[66:67]
    v_pk_fma_f32 v[88:89], v[88:89], v[128:129], s[68:69]
    v_pk_fma_f32 v[90:91], v[90:91], v[128:129], s[68:69]
    v_pk_fma_f32 v[92:93], v[92:93], v[128:129], s[68:69]
    v_pk_fma_f32 v[94:95], v[94:95], v[128:129], s[68:69]
    v_pk_mul_f32 v[88:89], v[88:89], v[60:61]
    v_pk_mul_f32 v[90:91], v[90:91], v[62:63]
    v_pk_mul_f32 v[92:93], v[92:93], v[64:65]
    v_pk_mul_f32 v[94:95], v[94:95], v[66:67]
    v_exp_f32 v88, v88
    v_exp_f32 v89, v89
    v_exp_f32 v90, v90
    v_exp_f32 v91, v91
    v_exp_f32 v92, v92
    v_exp_f32 v93, v93
    v_exp_f32 v94, v94
    v_exp_f32 v95, v95
    v_add_f32 v88, 1.0, v88
    v_add_f32 v89, 1.0, v89
    v_add_f32 v90, 1.0, v90
    v_add_f32 v91, 1.0, v91
    v_add_f32 v92, 1.0, v92
    v_add_f32 v93, 1.0, v93
    v_add_f32 v94, 1.0, v94
    v_add_f32 v95, 1.0, v95
    v_rcp_f32 v88, v88
    v_rcp_f32 v89, v89
    v_rcp_f32 v90, v90
    v_rcp_f32 v91, v91
    v_rcp_f32 v92, v92
    v_rcp_f32 v93, v93
    v_rcp_f32 v94, v94
    v_rcp_f32 v95, v95
    v_pk_mul_f32 v[60:61], v[60:61], v[88:89]
    v_pk_mul_f32 v[62:63], v[62:63], v[90:91]
    v_pk_mul_f32 v[64:65], v[64:65], v[92:93]
    v_pk_mul_f32 v[66:67], v[66:67], v[94:95]
    v_cvt_pk_bf16_f32 v36, v60, v61
    v_cvt_pk_bf16_f32 v37, v62, v63
    v_cvt_pk_bf16_f32 v38, v64, v65
    v_cvt_pk_bf16_f32 v39, v66, v67
    v_xor_b32 v139, 2048, v138
    buffer_store_dwordx4 v[36:39], v139, s[12:15], s52 offen sc1
    v_pk_fma_f32 v[88:89], v[154:155], v[80:81], v[104:105]
    v_pk_fma_f32 v[90:91], v[154:155], v[82:83], v[106:107]
    v_pk_fma_f32 v[92:93], v[154:155], v[84:85], v[108:109]
    v_pk_fma_f32 v[94:95], v[154:155], v[86:87], v[110:111]
    v_pk_fma_f32 v[68:69], v[68:69], v[152:153], v[88:89]
    v_pk_fma_f32 v[70:71], v[70:71], v[152:153], v[90:91]
    v_pk_fma_f32 v[72:73], v[72:73], v[152:153], v[92:93]
    v_pk_fma_f32 v[74:75], v[74:75], v[152:153], v[94:95]
    v_pk_mul_f32 v[88:89], v[68:69], v[68:69]
    v_pk_mul_f32 v[90:91], v[70:71], v[70:71]
    v_pk_mul_f32 v[92:93], v[72:73], v[72:73]
    v_pk_mul_f32 v[94:95], v[74:75], v[74:75]
    v_pk_fma_f32 v[88:89], v[88:89], v[128:129], s[68:69]
    v_pk_fma_f32 v[90:91], v[90:91], v[128:129], s[68:69]
    v_pk_fma_f32 v[92:93], v[92:93], v[128:129], s[68:69]
    v_pk_fma_f32 v[94:95], v[94:95], v[128:129], s[68:69]
    v_pk_mul_f32 v[88:89], v[88:89], v[68:69]
    v_pk_mul_f32 v[90:91], v[90:91], v[70:71]
    v_pk_mul_f32 v[92:93], v[92:93], v[72:73]
    v_pk_mul_f32 v[94:95], v[94:95], v[74:75]
    v_exp_f32 v88, v88
    v_exp_f32 v89, v89
    v_exp_f32 v90, v90
    v_exp_f32 v91, v91
    v_exp_f32 v92, v92
    v_exp_f32 v93, v93
    v_exp_f32 v94, v94
    v_exp_f32 v95, v95
    v_add_f32 v88, 1.0, v88
    v_add_f32 v89, 1.0, v89
    v_add_f32 v90, 1.0, v90
    v_add_f32 v91, 1.0, v91
    v_add_f32 v92, 1.0, v92
    v_add_f32 v93, 1.0, v93
    v_add_f32 v94, 1.0, v94
    v_add_f32 v95, 1.0, v95
    v_rcp_f32 v88, v88
    v_rcp_f32 v89, v89
    v_rcp_f32 v90, v90
    v_rcp_f32 v91, v91
    v_rcp_f32 v92, v92
    v_rcp_f32 v93, v93
    v_rcp_f32 v94, v94
    v_rcp_f32 v95, v95
    v_pk_mul_f32 v[68:69], v[68:69], v[88:89]
    v_pk_mul_f32 v[70:71], v[70:71], v[90:91]
    v_pk_mul_f32 v[72:73], v[72:73], v[92:93]
    v_pk_mul_f32 v[74:75], v[74:75], v[94:95]
    v_cvt_pk_bf16_f32 v40, v68, v69
    v_cvt_pk_bf16_f32 v41, v70, v71
    v_cvt_pk_bf16_f32 v42, v72, v73
    v_cvt_pk_bf16_f32 v43, v74, v75
    v_xor_b32 v139, 3072, v138
    buffer_store_dwordx4 v[40:43], v139, s[12:15], s52 offen sc1
    s_setprio 0
    s_branch L_p1done_2
L_typeF_1:
    s_add_u32 m0, s58, 0
    s_bfe_u32 s56, s59, 196608
    s_lshl_b32 s56, s56, 7
    buffer_load_dwordx4 v4, s[4:7], s56 offen offset:0 lds
    buffer_load_dwordx4 v5, s[4:7], s56 offen offset:1024 lds
    s_load_dwordx2 s[20:21], s[0:1], 40
    s_load_dwordx2 s[28:29], s[0:1], 56
    s_load_dwordx2 s[32:33], s[0:1], 64
    s_load_dwordx4 s[40:43], s[0:1], 8
    s_lshl3_add_u32 s50, s46, s47
    s_lshr_b32 s48, s44, 2
    s_and_b32 s49, s44, 3
    s_xor_b32 s73, s48, s46
    s_lshl1_add_u32 s62, s45, s46
    s_mov_b32 s65, s47
    s_mov_b32 s14, 18874368
    s_mov_b32 s15, 0x20000
    s_mov_b32 s26, 1835008
    s_mov_b32 s27, 0x20000
    s_add_u32 m0, s58, 32768
    s_bfe_u32 s56, s59, 196612
    s_lshl_b32 s56, s56, 7
    buffer_load_dwordx4 v4, s[4:7], s56 offen offset:0 lds
    buffer_load_dwordx4 v5, s[4:7], s56 offen offset:1024 lds
    v_lshrrev_b32 v12, 1, v1
    v_lshl_add_u32 v12, s50, 3, v12
    v_add_u32 v12, 1, v12
    v_cvt_f32_u32 v12, v12
    v_mul_f32 v12, 0x3b000000, v12
    v_and_b32 v13, 1, v1
    v_cvt_f32_u32 v13, v13
    v_mul_f32 v13, 0x3e800000, v13
    s_lshr_b32 s52, s44, 1
    s_lshl_b32 s52, s52, 2
    s_lshr_b32 s52, s59, s52
    s_and_b32 s52, s52, 7
    s_and_b32 s53, s44, 1
    s_lshl1_add_u32 s52, s52, s53
    v_lshl_add_u32 v14, s52, 2, v2
    v_lshlrev_b32 v14, 3, v14
    v_cvt_f32_u32 v14, v14
    v_fma_f32 v14, v14, v12, v13
    v_lshlrev_b32 v15, 10, v3
    v_lshl_add_u32 v15, v0, 4, v15
    v_add_u32 v15, 131072, v15
    v_fmamk_f32 v20, v12, 0x00000000, v14
    v_fmamk_f32 v21, v12, 0x3f800000, v14
    v_fmamk_f32 v22, v12, 0x40000000, v14
    v_fmamk_f32 v23, v12, 0x40400000, v14
    v_fmamk_f32 v24, v12, 0x40800000, v14
    v_fmamk_f32 v25, v12, 0x40a00000, v14
    v_fmamk_f32 v26, v12, 0x40c00000, v14
    v_fmamk_f32 v27, v12, 0x40e00000, v14
    v_cos_f32 v20, v20
    v_cos_f32 v21, v21
    v_cos_f32 v22, v22
    v_cos_f32 v23, v23
    v_cos_f32 v24, v24
    v_cos_f32 v25, v25
    v_cos_f32 v26, v26
    v_cos_f32 v27, v27
    v_cvt_pk_bf16_f32 v16, v20, v21
    v_cvt_pk_bf16_f32 v17, v22, v23
    v_cvt_pk_bf16_f32 v18, v24, v25
    v_cvt_pk_bf16_f32 v19, v26, v27
    ds_write_b128 v15, v[16:19]
    s_lshl_b32 s52, s46, 6
    s_add_u32 s52, s52, 129
    v_lshl_add_u32 v136, v136, 2, s52
    v_cvt_f32_u32 v136, v136
    v_mul_f32 v148, 0x3b000000, v136
    v_add_f32 v149, 0x3b000000, v148
    v_add_f32 v150, 0x3b800000, v148
    v_add_f32 v151, 0x3bc00000, v148
    v_lshl_add_u32 v153, v0, 4, s58
    v_add_u32 v154, 0x10000, v153
    s_bfe_u32 s52, s59, 196608
    v_lshl_add_u32 v24, s52, 6, v137
    v_cvt_f32_u32 v24, v24
    v_mul_f32 v12, v24, v148
    v_mul_f32 v13, v24, v149
    v_mul_f32 v14, v24, v150
    v_mul_f32 v15, v24, v151
    v_cos_f32 v16, v12
    v_sin_f32 v12, v12
    v_cos_f32 v17, v13
    v_sin_f32 v13, v13
    v_cos_f32 v18, v14
    v_sin_f32 v14, v14
    v_cos_f32 v19, v15
    v_sin_f32 v15, v15
    v_cvt_pk_bf16_f32 v28, v16, -v12
    v_cvt_pk_bf16_f32 v29, v17, -v13
    v_cvt_pk_bf16_f32 v30, v18, -v14
    v_cvt_pk_bf16_f32 v31, v19, -v15
    ds_write_b128 v153, v[28:31] offset:2048
    v_add_f32 v24, 4.0, v24
    v_mul_f32 v12, v24, v148
    v_mul_f32 v13, v24, v149
    v_mul_f32 v14, v24, v150
    v_mul_f32 v15, v24, v151
    v_cos_f32 v16, v12
    v_sin_f32 v12, v12
    v_cos_f32 v17, v13
    v_sin_f32 v13, v13
    v_cos_f32 v18, v14
    v_sin_f32 v14, v14
    v_cos_f32 v19, v15
    v_sin_f32 v15, v15
    v_cvt_pk_bf16_f32 v32, v16, -v12
    v_cvt_pk_bf16_f32 v33, v17, -v13
    v_cvt_pk_bf16_f32 v34, v18, -v14
    v_cvt_pk_bf16_f32 v35, v19, -v15
    ds_write_b128 v153, v[32:35] offset:3072
    s_bfe_u32 s52, s59, 196612
    v_lshl_add_u32 v24, s52, 6, v137
    v_cvt_f32_u32 v24, v24
    v_mul_f32 v12, v24, v148
    v_mul_f32 v13, v24, v149
    v_mul_f32 v14, v24, v150
    v_mul_f32 v15, v24, v151
    v_cos_f32 v16, v12
    v_sin_f32 v12, v12
    v_cos_f32 v17, v13
    v_sin_f32 v13, v13
    v_cos_f32 v18, v14
    v_sin_f32 v14, v14
    v_cos_f32 v19, v15
    v_sin_f32 v15, v15
    v_cvt_pk_bf16_f32 v28, v16, -v12
    v_cvt_pk_bf16_f32 v29, v17, -v13
    v_cvt_pk_bf16_f32 v30, v18, -v14
    v_cvt_pk_bf16_f32 v31, v19, -v15
    ds_write_b128 v153, v[28:31] offset:34816
    v_add_f32 v24, 4.0, v24
    v_mul_f32 v12, v24, v148
    v_mul_f32 v13, v24, v149
    v_mul_f32 v14, v24, v150
    v_mul_f32 v15, v24, v151
    v_cos_f32 v16, v12
    v_sin_f32 v12, v12
    v_cos_f32 v17, v13
    v_sin_f32 v13, v13
    v_cos_f32 v18, v14
    v_sin_f32 v14, v14
    v_cos_f32 v19, v15
    v_sin_f32 v15, v15
    v_cvt_pk_bf16_f32 v32, v16, -v12
    v_cvt_pk_bf16_f32 v33, v17, -v13
    v_cvt_pk_bf16_f32 v34, v18, -v14
    v_cvt_pk_bf16_f32 v35, v19, -v15
    ds_write_b128 v153, v[32:35] offset:35840
    s_bfe_u32 s52, s59, 196616
    v_lshl_add_u32 v24, s52, 6, v137
    v_cvt_f32_u32 v24, v24
    v_mul_f32 v12, v24, v148
    v_mul_f32 v13, v24, v149
    v_mul_f32 v14, v24, v150
    v_mul_f32 v15, v24, v151
    v_cos_f32 v16, v12
    v_sin_f32 v12, v12
    v_cos_f32 v17, v13
    v_sin_f32 v13, v13
    v_cos_f32 v18, v14
    v_sin_f32 v14, v14
    v_cos_f32 v19, v15
    v_sin_f32 v15, v15
    v_cvt_pk_bf16_f32 v28, v16, -v12
    v_cvt_pk_bf16_f32 v29, v17, -v13
    v_cvt_pk_bf16_f32 v30, v18, -v14
    v_cvt_pk_bf16_f32 v31, v19, -v15
    ds_write_b128 v154, v[28:31] offset:2048
    v_add_f32 v24, 4.0, v24
    v_mul_f32 v12, v24, v148
    v_mul_f32 v13, v24, v149
    v_mul_f32 v14, v24, v150
    v_mul_f32 v15, v24, v151
    v_cos_f32 v16, v12
    v_sin_f32 v12, v12
    v_cos_f32 v17, v13
    v_sin_f32 v13, v13
    v_cos_f32 v18, v14
    v_sin_f32 v14, v14
    v_cos_f32 v19, v15
    v_sin_f32 v15, v15
    v_cvt_pk_bf16_f32 v32, v16, -v12
    v_cvt_pk_bf16_f32 v33, v17, -v13
    v_cvt_pk_bf16_f32 v34, v18, -v14
    v_cvt_pk_bf16_f32 v35, v19, -v15
    ds_write_b128 v154, v[32:35] offset:3072
    s_bfe_u32 s52, s59, 196620
    v_lshl_add_u32 v24, s52, 6, v137
    v_cvt_f32_u32 v24, v24
    v_mul_f32 v12, v24, v148
    v_mul_f32 v13, v24, v149
    v_mul_f32 v14, v24, v150
    v_mul_f32 v15, v24, v151
    v_cos_f32 v16, v12
    v_sin_f32 v12, v12
    v_cos_f32 v17, v13
    v_sin_f32 v13, v13
    v_cos_f32 v18, v14
    v_sin_f32 v14, v14
    v_cos_f32 v19, v15
    v_sin_f32 v15, v15
    v_cvt_pk_bf16_f32 v28, v16, -v12
    v_cvt_pk_bf16_f32 v29, v17, -v13
    v_cvt_pk_bf16_f32 v30, v18, -v14
    v_cvt_pk_bf16_f32 v31, v19, -v15
    ds_write_b128 v154, v[28:31] offset:34816
    v_add_f32 v24, 4.0, v24
    v_mul_f32 v12, v24, v148
    v_mul_f32 v13, v24, v149
    v_mul_f32 v14, v24, v150
    v_mul_f32 v15, v24, v151
    v_cos_f32 v16, v12
    v_sin_f32 v12, v12
    v_cos_f32 v17, v13
    v_sin_f32 v13, v13
    v_cos_f32 v18, v14
    v_sin_f32 v14, v14
    v_cos_f32 v19, v15
    v_sin_f32 v15, v15
    v_cvt_pk_bf16_f32 v32, v16, -v12
    v_cvt_pk_bf16_f32 v33, v17, -v13
    v_cvt_pk_bf16_f32 v34, v18, -v14
    v_cvt_pk_bf16_f32 v35, v19, -v15
    ds_write_b128 v154, v[32:35] offset:35840
    v_lshrrev_b32 v88, 1, v1
    v_and_b32 v89, 4, v3
    v_or_b32 v90, v89, v2
    v_xor_b32 v88, v88, v90
    v_lshlrev_b32 v88, 4, v88
    v_lshl_add_u32 v88, v1, 7, v88
    v_lshl_add_u32 v88, s73, 12, v88
    v_and_b32 v91, 3, v3
    v_lshl_add_u32 v112, v91, 13, v88
    v_xor_b32 v113, 8192, v112
    v_xor_b32 v114, 16384, v112
    v_xor_b32 v115, 24576, v112
    v_xor_b32 v116, 64, v112
    v_xor_b32 v117, 64, v113
    v_xor_b32 v118, 64, v114
    v_xor_b32 v119, 64, v115
    v_lshrrev_b32 v88, 2, v1
    v_and_b32 v93, 3, v1
    v_and_b32 v92, 1, v2
    v_lshl_or_b32 v92, v92, 2, v88
    v_lshlrev_b32 v91, 1, v91
    v_xor_b32 v92, v91, v92
    v_lshlrev_b32 v88, 8, v88
    v_lshl_add_u32 v88, v90, 12, v88
    v_lshl_add_u32 v88, v92, 5, v88
    v_lshl_add_u32 v88, v93, 3, v88
    v_add_u32 v120, 2048, v88
    v_xor_b32 v121, 32, v120
    v_xor_b32 v122, 0x4000, v120
    v_xor_b32 v123, 0x4000, v121
    v_lshlrev_b32 v89, 8, v89
    v_lshl_add_u32 v89, v0, 4, v89
    v_add_u32 v8, 131072, v89
    v_xor_b32 v9, 0x400, v8
    v_mov_b32 v128, 0x3f803f80
    v_mov_b32 v129, 0x3f803f80
    v_mov_b32 v130, 0x3f803f80
    v_mov_b32 v131, 0x3f803f80
    s_waitcnt lgkmcnt(0)
    s_mul_i32 s80, s46, 28
    s_add_u32 s80, s80, s49
    v_lshl_add_u32 v141, s80, 5, v132
    v_lshlrev_b32 v141, 10, v141
    v_lshlrev_b32 v142, 1, v2
    v_xor_b32 v142, v142, v133
    v_lshl_add_u32 v141, v142, 4, v141
    v_lshl_add_u32 v252, s65, 7, v141
    s_cmp_eq_u32 s48, 0
    s_cselect_b64 s[16:17], s[40:41], s[42:43]
    s_mov_b32 s18, 1052672
    s_mov_b32 s19, 0x20000
    s_lshl2_add_u32 s80, s47, s49
    s_and_b32 s81, s2, 7
    s_lshl3_add_u32 s80, s80, s81
    s_mul_i32 s80, s80, 4112
    s_bfe_u32 s81, s2, 0x20003
    s_lshl_b32 s81, s81, 7
    s_add_u32 s80, s80, s81
    s_add_u32 s80, s80, 2
    v_xor_b32 v140, v132, v133
    v_mul_u32_u24 v141, 514, v132
    v_lshl_add_u32 v141, v140, 4, v141
    v_add_u32 v246, s80, v141
    v_xor_b32 v140, v3, v133
    v_lshlrev_b32 v140, 4, v140
    v_lshl_add_u32 v140, v133, 7, v140
    v_lshl_add_u32 v140, v132, 1, v140
    v_add_u32 v244, 139264, v140
    s_bfe_u32 s80, s2, 0x20003
    s_lshl3_add_u32 s80, s80, s44
    v_lshl_add_u32 v140, s80, 3, v132
    v_mul_u32_u24 v140, 8448, v140
    v_lshl_add_u32 v140, v133, 4, v140
    s_lshl_b32 s80, s80, 5
    s_bfe_u32 s81, s2, 0x20001
    s_add_u32 s80, s80, s81
    s_lshl3_add_u32 s80, s80, s47
    s_lshl1_add_u32 s80, s80, s46
    s_lshl3_add_u32 s80, s80, 14942208
    v_lshl_add_u32 v250, v0, 9, s80
    s_lshr_b32 s80, s2, 7
    s_bfe_u32 s81, s2, 0x20001
    s_lshl2_add_u32 s80, s80, s81
    s_bfe_u32 s81, s2, 0x20005
    s_lshl2_add_u32 s80, s80, s81
    s_lshl1_add_u32 s80, s80, s46
    s_lshl_b32 s80, s80, 7
    s_add_u32 s80, s80, 4718592
    v_add_u32 v245, s80, v140
    s_lshl3_add_u32 s80, s50, s44
    s_lshl4_add_u32 s80, s80, s45
    s_lshl_b32 s80, s80, 5
    s_add_u32 s80, s80, 14811136
    v_writelane_b32 v250, s80, 8
    s_add_u32 s80, s80, 16
    v_writelane_b32 v250, s80, 9
    s_lshl1_add_u32 s66, s45, s73
    s_lshl_b32 s80, s62, 6
    s_add_u32 s80, s80, s44
    s_lshl3_add_u32 s80, s80, s47
    s_lshl4_add_u32 s80, s80, 15204352
    v_lshl_add_u32 v254, v0, 10, s80
    s_lshl_b32 s66, s66, 8
    v_lshrrev_b32 v140, 2, v1
    v_lshl_add_u32 v140, v140, 4, v1
    v_lshlrev_b32 v247, 2, v140
    s_lshl1_add_u32 s80, s49, s48
    s_lshl_b32 s80, s80, 8
    s_add_u32 s80, s80, 153600
    v_lshl_add_u32 v248, v1, 4, s80
    s_lshl_b32 s80, s73, 8
    s_lshl2_add_u32 s80, s49, s80
    s_add_u32 s80, s80, 147456
    v_lshlrev_b32 v140, 10, v2
    v_lshl_add_u32 v140, v1, 4, v140
    v_add_u32 v249, s80, v140
    v_and_b32 v140, 3, v1
    v_cmp_eq_u32 s[74:75], 1, v140
    v_cmp_eq_u32 s[76:77], 2, v140
    v_cmp_eq_u32 s[78:79], 3, v140
    s_lshl3_add_u32 s72, s50, s44
    s_mul_i32 s72, s72, 8448
    s_lshl_b32 s80, s45, 9
    s_add_u32 s72, s72, s80
    v_mov_b32 v140, 152576
    v_mov_b32 v144, 0
    v_mov_b32 v145, 0
    v_mov_b32 v146, 0
    v_mov_b32 v147, 0
    ds_write_b128 v140, v[144:147]
    ds_write_b128 v140, v[144:147] offset:16
    ds_write_b128 v140, v[144:147] offset:32
    s_add_u32 m0, s58, 65536
    s_bfe_u32 s56, s59, 196616
    s_lshl_b32 s56, s56, 7
    buffer_load_dwordx4 v4, s[4:7], s56 offen offset:0 lds
    buffer_load_dwordx4 v5, s[4:7], s56 offen offset:1024 lds
    v_mov_b32 v255, 14680064
    buffer_load_dword v255, v255, s[12:15], 0 offen sc1
    s_waitcnt vmcnt(5)
    s_waitcnt lgkmcnt(0)
    s_barrier
    ds_read_b64_tr_b16 v[88:89], v120 offset:0
    ds_read_b64_tr_b16 v[90:91], v120 offset:1024
    ds_read_b128 v[12:15], v112 offset:0
    ds_read_b64_tr_b16 v[92:93], v121 offset:0
    ds_read_b64_tr_b16 v[94:95], v121 offset:1024
    ds_read_b128 v[16:19], v113 offset:0
    ds_read_b128 v[20:23], v114 offset:0
    ds_read_b128 v[24:27], v115 offset:0
    ds_read_b128 v[104:107], v8 offset:0
    s_waitcnt lgkmcnt(0)
    v_mfma_f32_16x16x32_bf16 v[44:47], v[88:91], v[12:15], 0
    ds_read_b64_tr_b16 v[96:97], v122 offset:0
    v_mfma_f32_16x16x32_bf16 v[48:51], v[92:95], v[12:15], 0
    ds_read_b64_tr_b16 v[98:99], v122 offset:1024
    v_mfma_f32_16x16x32_bf16 v[52:55], v[88:91], v[16:19], 0
    ds_read_b128 v[28:31], v116 offset:0
    s_add_u32 m0, s58, 98304
    s_bfe_u32 s56, s59, 196620
    s_lshl_b32 s56, s56, 7
    buffer_load_dwordx4 v4, s[4:7], s56 offen offset:0 lds
    v_mfma_f32_16x16x32_bf16 v[56:59], v[92:95], v[16:19], 0
    ds_read_b64_tr_b16 v[100:101], v123 offset:0
    v_mfma_f32_16x16x32_bf16 v[60:63], v[88:91], v[20:23], 0
    ds_read_b64_tr_b16 v[102:103], v123 offset:1024
    v_mfma_f32_16x16x32_bf16 v[64:67], v[92:95], v[20:23], 0
    ds_read_b128 v[32:35], v117 offset:0
    v_mfma_f32_16x16x32_bf16 v[68:71], v[88:91], v[24:27], 0
    ds_read_b128 v[36:39], v118 offset:0
    v_mfma_f32_16x16x32_bf16 v[72:75], v[92:95], v[24:27], 0
    ds_read_b128 v[40:43], v119 offset:0
    v_mfma_f32_16x16x32_bf16 v[152:155], v[12:15], v[12:15], 0
    ds_read_b128 v[108:111], v9 offset:0
    buffer_load_dwordx4 v5, s[4:7], s56 offen offset:1024 lds
    v_mfma_f32_16x16x32_bf16 v[148:151], v[128:131], v[12:15], 0
    v_mfma_f32_16x16x32_bf16 v[76:79], v[104:107], v[12:15], 0
    s_waitcnt vmcnt(5)
    s_waitcnt lgkmcnt(0)
    s_barrier
    v_mfma_f32_16x16x32_bf16 v[44:47], v[96:99], v[28:31], v[44:47]
    ds_read_b64_tr_b16 v[88:89], v120 offset:32768
    v_mfma_f32_16x16x32_bf16 v[48:51], v[100:103], v[28:31], v[48:51]
    ds_read_b64_tr_b16 v[90:91], v120 offset:33792
    v_mfma_f32_16x16x32_bf16 v[52:55], v[96:99], v[32:35], v[52:55]
    ds_read_b128 v[12:15], v112 offset:32768
    v_mfma_f32_16x16x32_bf16 v[56:59], v[100:103], v[32:35], v[56:59]
    ds_read_b64_tr_b16 v[92:93], v121 offset:32768
    v_mfma_f32_16x16x32_bf16 v[60:63], v[96:99], v[36:39], v[60:63]
    ds_read_b64_tr_b16 v[94:95], v121 offset:33792
    v_mfma_f32_16x16x32_bf16 v[64:67], v[100:103], v[36:39], v[64:67]
    ds_read_b128 v[16:19], v113 offset:32768
    s_add_u32 m0, s58, 0
    s_bfe_u32 s56, s59, 196608
    s_xor_b32 s56, s56, 4
    s_lshl_b32 s56, s56, 7
    buffer_load_dwordx4 v4, s[4:7], s56 offen offset:0 lds
    v_mfma_f32_16x16x32_bf16 v[68:71], v[96:99], v[40:43], v[68:71]
    ds_read_b128 v[20:23], v114 offset:32768
    v_mfma_f32_16x16x32_bf16 v[72:75], v[100:103], v[40:43], v[72:75]
    ds_read_b128 v[24:27], v115 offset:32768
    v_mfma_f32_16x16x32_bf16 v[152:155], v[28:31], v[28:31], v[152:155]
    ds_read_b128 v[104:107], v8 offset:2048
    v_mfma_f32_16x16x32_bf16 v[148:151], v[128:131], v[28:31], v[148:151]
    v_mfma_f32_16x16x32_bf16 v[76:79], v[108:111], v[28:31], v[76:79]
    s_waitcnt lgkmcnt(0)
    v_mfma_f32_16x16x32_bf16 v[44:47], v[88:91], v[12:15], v[44:47]
    ds_read_b64_tr_b16 v[96:97], v122 offset:32768
    v_mfma_f32_16x16x32_bf16 v[48:51], v[92:95], v[12:15], v[48:51]
    ds_read_b64_tr_b16 v[98:99], v122 offset:33792
    buffer_load_dwordx4 v5, s[4:7], s56 offen offset:1024 lds
    v_mfma_f32_16x16x32_bf16 v[52:55], v[88:91], v[16:19], v[52:55]
    ds_read_b128 v[28:31], v116 offset:32768
    v_mfma_f32_16x16x32_bf16 v[56:59], v[92:95], v[16:19], v[56:59]
    ds_read_b64_tr_b16 v[100:101], v123 offset:32768
    v_mfma_f32_16x16x32_bf16 v[60:63], v[88:91], v[20:23], v[60:63]
    ds_read_b64_tr_b16 v[102:103], v123 offset:33792
    v_mfma_f32_16x16x32_bf16 v[64:67], v[92:95], v[20:23], v[64:67]
    ds_read_b128 v[32:35], v117 offset:32768
    s_lshl3_add_u32 s52, s2, s44
    s_mul_i32 s52, s52, 896
    v_lshlrev_b32 v11, 7, v0
    s_mov_b64 exec, 0x7f
    buffer_load_dword v10, v11, s[24:27], s52 offen
    s_mov_b64 exec, -1
    v_mfma_f32_16x16x32_bf16 v[68:71], v[88:91], v[24:27], v[68:71]
    ds_read_b128 v[36:39], v118 offset:32768
    v_mfma_f32_16x16x32_bf16 v[72:75], v[92:95], v[24:27], v[72:75]
    ds_read_b128 v[40:43], v119 offset:32768
    v_mfma_f32_16x16x32_bf16 v[152:155], v[12:15], v[12:15], v[152:155]
    ds_read_b128 v[108:111], v9 offset:2048
    v_mfma_f32_16x16x32_bf16 v[148:151], v[128:131], v[12:15], v[148:151]
    s_lshr_b32 s52, s58, 2
    s_add_u32 m0, s52, 139264
    s_nop 0
    buffer_load_dwordx4 v246, s[16:19], 0 offen lds
    v_mfma_f32_16x16x32_bf16 v[76:79], v[104:107], v[12:15], v[76:79]
    s_waitcnt vmcnt(7)
    s_waitcnt lgkmcnt(0)
    s_barrier
    v_xor_b32 v112, 0x10000, v112
    v_xor_b32 v113, 0x10000, v113
    v_xor_b32 v114, 0x10000, v114
    v_xor_b32 v115, 0x10000, v115
    v_xor_b32 v120, 0x10000, v120
    v_xor_b32 v121, 0x10000, v121
    v_mfma_f32_16x16x32_bf16 v[44:47], v[96:99], v[28:31], v[44:47]
    ds_read_b64_tr_b16 v[88:89], v120 offset:0
    s_cmp_eq_u32 s47, 7
    s_cselect_b32 s36, 0, s47
    v_mfma_f32_16x16x32_bf16 v[48:51], v[100:103], v[28:31], v[48:51]
    ds_read_b64_tr_b16 v[90:91], v120 offset:1024
    s_lshl_b32 s36, s36, 14
    v_mfma_f32_16x16x32_bf16 v[52:55], v[96:99], v[32:35], v[52:55]
    ds_read_b128 v[12:15], v112 offset:0
    s_add_u32 s37, s36, 16384
    v_mfma_f32_16x16x32_bf16 v[56:59], v[100:103], v[32:35], v[56:59]
    ds_read_b64_tr_b16 v[92:93], v121 offset:0
    s_cmp_eq_u32 s37, 114688
    s_cselect_b32 s37, 0, s37
    v_mfma_f32_16x16x32_bf16 v[60:63], v[96:99], v[36:39], v[60:63]
    ds_read_b64_tr_b16 v[94:95], v121 offset:1024
    s_add_u32 s38, s37, 16384
    v_mfma_f32_16x16x32_bf16 v[64:67], v[100:103], v[36:39], v[64:67]
    ds_read_b128 v[16:19], v113 offset:0
    s_add_u32 m0, s58, 32768
    s_bfe_u32 s56, s59, 196612
    s_xor_b32 s56, s56, 4
    s_lshl_b32 s56, s56, 7
    buffer_load_dwordx4 v4, s[4:7], s56 offen offset:0 lds
    s_cmp_eq_u32 s38, 114688
    s_cselect_b32 s38, 0, s38
    v_mfma_f32_16x16x32_bf16 v[68:71], v[96:99], v[40:43], v[68:71]
    ds_read_b128 v[20:23], v114 offset:0
    s_add_u32 s39, s38, 16384
    v_mfma_f32_16x16x32_bf16 v[72:75], v[100:103], v[40:43], v[72:75]
    ds_read_b128 v[24:27], v115 offset:0
    s_cmp_eq_u32 s39, 114688
    s_cselect_b32 s39, 0, s39
    v_mfma_f32_16x16x32_bf16 v[152:155], v[28:31], v[28:31], v[152:155]
    ds_read_b128 v[104:107], v8 offset:4096
    v_mfma_f32_16x16x32_bf16 v[148:151], v[128:131], v[28:31], v[148:151]
    v_mfma_f32_16x16x32_bf16 v[76:79], v[108:111], v[28:31], v[76:79]
    v_xor_b32 v116, 0x10000, v116
    v_xor_b32 v117, 0x10000, v117
    v_xor_b32 v118, 0x10000, v118
    v_xor_b32 v119, 0x10000, v119
    v_xor_b32 v122, 0x10000, v122
    v_xor_b32 v123, 0x10000, v123
    s_waitcnt lgkmcnt(0)
    v_mfma_f32_16x16x32_bf16 v[44:47], v[88:91], v[12:15], v[44:47]
    ds_read_b64_tr_b16 v[96:97], v122 offset:0
    s_add_u32 s60, s39, 16384
    v_mfma_f32_16x16x32_bf16 v[48:51], v[92:95], v[12:15], v[48:51]
    ds_read_b64_tr_b16 v[98:99], v122 offset:1024
    s_cmp_eq_u32 s60, 114688
    s_cselect_b32 s60, 0, s60
    v_mfma_f32_16x16x32_bf16 v[52:55], v[88:91], v[16:19], v[52:55]
    ds_read_b128 v[28:31], v116 offset:0
    s_add_u32 s67, s60, 16384
    v_mfma_f32_16x16x32_bf16 v[56:59], v[92:95], v[16:19], v[56:59]
    ds_read_b64_tr_b16 v[100:101], v123 offset:0
    s_cmp_eq_u32 s67, 114688
    s_cselect_b32 s67, 0, s67
    v_mfma_f32_16x16x32_bf16 v[60:63], v[88:91], v[20:23], v[60:63]
    ds_read_b64_tr_b16 v[102:103], v123 offset:1024
    s_add_u32 s70, s67, 16384
    v_mfma_f32_16x16x32_bf16 v[64:67], v[92:95], v[20:23], v[64:67]
    ds_read_b128 v[32:35], v117 offset:0
    buffer_load_dwordx4 v5, s[4:7], s56 offen offset:1024 lds
    s_cmp_eq_u32 s70, 114688
    s_cselect_b32 s70, 0, s70
    v_mfma_f32_16x16x32_bf16 v[68:71], v[88:91], v[24:27], v[68:71]
    ds_read_b128 v[36:39], v118 offset:0
    s_cmp_eq_u32 s48, 0
    s_cselect_b32 s82, s39, s36
    s_cselect_b32 s83, s60, s37
    s_cselect_b32 s84, s67, s38
    s_cselect_b32 s85, s70, s39
    v_mfma_f32_16x16x32_bf16 v[72:75], v[92:95], v[24:27], v[72:75]
    ds_read_b128 v[40:43], v119 offset:0
    v_mfma_f32_16x16x32_bf16 v[152:155], v[12:15], v[12:15], v[152:155]
    ds_read_b128 v[108:111], v9 offset:4096
    v_mfma_f32_16x16x32_bf16 v[148:151], v[128:131], v[12:15], v[148:151]
    v_mfma_f32_16x16x32_bf16 v[76:79], v[104:107], v[12:15], v[76:79]
    s_waitcnt vmcnt(6)
    s_mov_b32 s52, 0x9e3779b1
    v_mul_lo_u32 v255, v255, s52
    v_add_u32 v255, 0x632be5ab, v255
    s_waitcnt lgkmcnt(0)
    s_barrier
    v_mfma_f32_16x16x32_bf16 v[44:47], v[96:99], v[28:31], v[44:47]
    ds_read_b64_tr_b16 v[88:89], v120 offset:32768
    v_mfma_f32_16x16x32_bf16 v[48:51], v[100:103], v[28:31], v[48:51]
    ds_read_b64_tr_b16 v[90:91], v120 offset:33792
    v_mfma_f32_16x16x32_bf16 v[52:55], v[96:99], v[32:35], v[52:55]
    ds_read_b128 v[12:15], v112 offset:32768
    v_mfma_f32_16x16x32_bf16 v[56:59], v[100:103], v[32:35], v[56:59]
    ds_read_b64_tr_b16 v[92:93], v121 offset:32768
    v_mfma_f32_16x16x32_bf16 v[60:63], v[96:99], v[36:39], v[60:63]
    ds_read_b64_tr_b16 v[94:95], v121 offset:33792
    v_mfma_f32_16x16x32_bf16 v[64:67], v[100:103], v[36:39], v[64:67]
    ds_read_b128 v[16:19], v113 offset:32768
    s_add_u32 m0, s58, 65536
    s_bfe_u32 s56, s59, 196616
    s_xor_b32 s56, s56, 4
    s_lshl_b32 s56, s56, 7
    buffer_load_dwordx4 v4, s[4:7], s56 offen offset:0 lds
    v_mfma_f32_16x16x32_bf16 v[68:71], v[96:99], v[40:43], v[68:71]
    ds_read_b128 v[20:23], v114 offset:32768
    v_mfma_f32_16x16x32_bf16 v[72:75], v[100:103], v[40:43], v[72:75]
    ds_read_b128 v[24:27], v115 offset:32768
    v_mfma_f32_16x16x32_bf16 v[152:155], v[28:31], v[28:31], v[152:155]
    ds_read_b128 v[104:107], v8 offset:6144
    v_mfma_f32_16x16x32_bf16 v[148:151], v[128:131], v[28:31], v[148:151]
    v_mfma_f32_16x16x32_bf16 v[76:79], v[108:111], v[28:31], v[76:79]
    s_waitcnt lgkmcnt(0)
    v_mfma_f32_16x16x32_bf16 v[44:47], v[88:91], v[12:15], v[44:47]
    ds_read_b64_tr_b16 v[96:97], v122 offset:32768
    v_mfma_f32_16x16x32_bf16 v[48:51], v[92:95], v[12:15], v[48:51]
    ds_read_b64_tr_b16 v[98:99], v122 offset:33792
    v_mfma_f32_16x16x32_bf16 v[52:55], v[88:91], v[16:19], v[52:55]
    ds_read_b128 v[28:31], v116 offset:32768
    buffer_load_dwordx4 v5, s[4:7], s56 offen offset:1024 lds
    v_mfma_f32_16x16x32_bf16 v[56:59], v[92:95], v[16:19], v[56:59]
    ds_read_b64_tr_b16 v[100:101], v123 offset:32768
    v_mfma_f32_16x16x32_bf16 v[60:63], v[88:91], v[20:23], v[60:63]
    ds_read_b64_tr_b16 v[102:103], v123 offset:33792
    v_mfma_f32_16x16x32_bf16 v[64:67], v[92:95], v[20:23], v[64:67]
    ds_read_b128 v[32:35], v117 offset:32768
    v_mfma_f32_16x16x32_bf16 v[68:71], v[88:91], v[24:27], v[68:71]
    ds_read_b128 v[36:39], v118 offset:32768
    v_mfma_f32_16x16x32_bf16 v[72:75], v[92:95], v[24:27], v[72:75]
    ds_read_b128 v[40:43], v119 offset:32768
    v_mfma_f32_16x16x32_bf16 v[152:155], v[12:15], v[12:15], v[152:155]
    ds_read_b128 v[108:111], v9 offset:6144
    v_mov_b32 v236, -1
    v_mov_b32 v237, -1
    v_mov_b32 v238, -1
    v_mov_b32 v239, -1
    s_mul_i32 s52, s2, 8448
    s_add_u32 s52, s52, 2359296
    s_lshl_b32 s53, s2, 13
    s_add_u32 s53, s53, 16777216
    s_cmp_eq_u32 s48, 0
    s_cselect_b32 s52, s52, s53
    v_lshl_add_u32 v240, v0, 4, s52
    v_lshl_add_u32 v240, s49, 11, v240
    buffer_store_dwordx4 v[236:239], v240, s[12:15], 0 offen offset:0 sc1
    v_mfma_f32_16x16x32_bf16 v[148:151], v[128:131], v[12:15], v[148:151]
    v_mfma_f32_16x16x32_bf16 v[76:79], v[104:107], v[12:15], v[76:79]
    s_waitcnt vmcnt(7)
    s_waitcnt vmcnt(5)
    s_waitcnt lgkmcnt(0)
    s_barrier
    v_xor_b32 v112, 0x10000, v112
    v_xor_b32 v113, 0x10000, v113
    v_xor_b32 v114, 0x10000, v114
    v_xor_b32 v115, 0x10000, v115
    v_xor_b32 v120, 0x10000, v120
    v_xor_b32 v121, 0x10000, v121
    v_mfma_f32_16x16x32_bf16 v[44:47], v[96:99], v[28:31], v[44:47]
    ds_read_b64_tr_b16 v[88:89], v120 offset:0
    v_mfma_f32_16x16x32_bf16 v[48:51], v[100:103], v[28:31], v[48:51]
    ds_read_b64_tr_b16 v[90:91], v120 offset:1024
    v_mfma_f32_16x16x32_bf16 v[52:55], v[96:99], v[32:35], v[52:55]
    ds_read_b128 v[12:15], v112 offset:0
    v_mfma_f32_16x16x32_bf16 v[56:59], v[100:103], v[32:35], v[56:59]
    ds_read_b64_tr_b16 v[92:93], v121 offset:0
    v_mfma_f32_16x16x32_bf16 v[60:63], v[96:99], v[36:39], v[60:63]
    ds_read_b64_tr_b16 v[94:95], v121 offset:1024
    v_mfma_f32_16x16x32_bf16 v[64:67], v[100:103], v[36:39], v[64:67]
    ds_read_b128 v[16:19], v113 offset:0
    s_add_u32 m0, s58, 98304
    s_bfe_u32 s56, s59, 196620
    s_xor_b32 s56, s56, 4
    s_lshl_b32 s56, s56, 7
    buffer_load_dwordx4 v4, s[4:7], s56 offen offset:0 lds
    v_mfma_f32_16x16x32_bf16 v[68:71], v[96:99], v[40:43], v[68:71]
    ds_read_b128 v[20:23], v114 offset:0
    v_mfma_f32_16x16x32_bf16 v[72:75], v[100:103], v[40:43], v[72:75]
    ds_read_b128 v[24:27], v115 offset:0
    v_mfma_f32_16x16x32_bf16 v[152:155], v[28:31], v[28:31], v[152:155]
    ds_read_b128 v[104:107], v8 offset:0
    v_mfma_f32_16x16x32_bf16 v[148:151], v[128:131], v[28:31], v[148:151]
    ds_read_u16 v140, v244 offset:0
    v_mfma_f32_16x16x32_bf16 v[76:79], v[108:111], v[28:31], v[76:79]
    ds_read_u16 v144, v244 offset:4096
    ds_read_u16 v141, v244 offset:1024
    ds_read_u16 v145, v244 offset:5120
    ds_read_u16 v142, v244 offset:2048
    ds_read_u16 v146, v244 offset:6144
    ds_read_u16 v143, v244 offset:3072
    ds_read_u16 v147, v244 offset:7168
    v_xor_b32 v116, 0x10000, v116
    v_xor_b32 v117, 0x10000, v117
    v_xor_b32 v118, 0x10000, v118
    v_xor_b32 v119, 0x10000, v119
    v_xor_b32 v122, 0x10000, v122
    v_xor_b32 v123, 0x10000, v123
    s_waitcnt lgkmcnt(0)
    v_xor_b32 v44, 0x80000000, v44
    v_xor_b32 v45, 0x80000000, v45
    v_xor_b32 v48, 0x80000000, v48
    v_xor_b32 v49, 0x80000000, v49
    v_xor_b32 v52, 0x80000000, v52
    v_xor_b32 v53, 0x80000000, v53
    v_xor_b32 v56, 0x80000000, v56
    v_xor_b32 v57, 0x80000000, v57
    v_xor_b32 v60, 0x80000000, v60
    v_xor_b32 v61, 0x80000000, v61
    v_xor_b32 v64, 0x80000000, v64
    v_xor_b32 v65, 0x80000000, v65
    v_xor_b32 v68, 0x80000000, v68
    v_xor_b32 v69, 0x80000000, v69
    v_xor_b32 v72, 0x80000000, v72
    v_xor_b32 v73, 0x80000000, v73
    v_xor_b32 v76, 0x80000000, v76
    v_xor_b32 v77, 0x80000000, v77
    v_mfma_f32_16x16x32_bf16 v[44:47], v[88:91], v[12:15], v[44:47]
    ds_read_b64_tr_b16 v[96:97], v122 offset:0
    v_mfma_f32_16x16x32_bf16 v[48:51], v[92:95], v[12:15], v[48:51]
    ds_read_b64_tr_b16 v[98:99], v122 offset:1024
    v_mfma_f32_16x16x32_bf16 v[52:55], v[88:91], v[16:19], v[52:55]
    ds_read_b128 v[28:31], v116 offset:0
    buffer_load_dwordx4 v5, s[4:7], s56 offen offset:1024 lds
    v_mfma_f32_16x16x32_bf16 v[56:59], v[92:95], v[16:19], v[56:59]
    ds_read_b64_tr_b16 v[100:101], v123 offset:0
    v_mfma_f32_16x16x32_bf16 v[60:63], v[88:91], v[20:23], v[60:63]
    ds_read_b64_tr_b16 v[102:103], v123 offset:1024
    v_mfma_f32_16x16x32_bf16 v[64:67], v[92:95], v[20:23], v[64:67]
    ds_read_b128 v[32:35], v117 offset:0
    v_mfma_f32_16x16x32_bf16 v[68:71], v[88:91], v[24:27], v[68:71]
    ds_read_b128 v[36:39], v118 offset:0
    v_mfma_f32_16x16x32_bf16 v[72:75], v[92:95], v[24:27], v[72:75]
    ds_read_b128 v[40:43], v119 offset:0
    v_mfma_f32_16x16x32_bf16 v[152:155], v[12:15], v[12:15], v[152:155]
    ds_read_b128 v[108:111], v9 offset:0
    v_lshl_or_b32 v140, v144, 16, v140
    v_lshl_or_b32 v141, v145, 16, v141
    v_lshl_or_b32 v142, v146, 16, v142
    v_lshl_or_b32 v143, v147, 16, v143
    buffer_store_dwordx4 v[140:143], v245, s[12:15], 0 offen sc1
    v_mfma_f32_16x16x32_bf16 v[148:151], v[128:131], v[12:15], v[148:151]
    v_mfma_f32_16x16x32_bf16 v[76:79], v[104:107], v[12:15], v[76:79]
    s_waitcnt vmcnt(6)
    s_waitcnt lgkmcnt(0)
    s_barrier
    v_mfma_f32_16x16x32_bf16 v[44:47], v[96:99], v[28:31], v[44:47]
    ds_read_b64_tr_b16 v[88:89], v120 offset:32768
    v_mfma_f32_16x16x32_bf16 v[48:51], v[100:103], v[28:31], v[48:51]
    ds_read_b64_tr_b16 v[90:91], v120 offset:33792
    v_mfma_f32_16x16x32_bf16 v[52:55], v[96:99], v[32:35], v[52:55]
    ds_read_b128 v[12:15], v112 offset:32768
    s_add_u32 m0, s58, 0
    s_lshl3_add_u32 s63, s82, 0
    buffer_load_dwordx4 v252, s[24:27], s63 offen offset:0 lds
    v_mfma_f32_16x16x32_bf16 v[56:59], v[100:103], v[32:35], v[56:59]
    ds_read_b64_tr_b16 v[92:93], v121 offset:32768
    v_mfma_f32_16x16x32_bf16 v[60:63], v[96:99], v[36:39], v[60:63]
    ds_read_b64_tr_b16 v[94:95], v121 offset:33792
    v_mfma_f32_16x16x32_bf16 v[64:67], v[100:103], v[36:39], v[64:67]
    ds_read_b128 v[16:19], v113 offset:32768
    v_mfma_f32_16x16x32_bf16 v[68:71], v[96:99], v[40:43], v[68:71]
    ds_read_b128 v[20:23], v114 offset:32768
    v_mfma_f32_16x16x32_bf16 v[72:75], v[100:103], v[40:43], v[72:75]
    ds_read_b128 v[24:27], v115 offset:32768
    v_mfma_f32_16x16x32_bf16 v[152:155], v[28:31], v[28:31], v[152:155]
    ds_read_b128 v[104:107], v8 offset:2048
    s_lshl3_add_u32 s63, s82, 7168
    buffer_load_dwordx4 v252, s[24:27], s63 offen offset:1024 lds
    v_mfma_f32_16x16x32_bf16 v[148:151], v[128:131], v[28:31], v[148:151]
    v_mfma_f32_16x16x32_bf16 v[76:79], v[108:111], v[28:31], v[76:79]
    s_waitcnt lgkmcnt(0)
    v_mfma_f32_16x16x32_bf16 v[44:47], v[88:91], v[12:15], v[44:47]
    ds_read_b64_tr_b16 v[96:97], v122 offset:32768
    v_mfma_f32_16x16x32_bf16 v[48:51], v[92:95], v[12:15], v[48:51]
    ds_read_b64_tr_b16 v[98:99], v122 offset:33792
    v_mfma_f32_16x16x32_bf16 v[52:55], v[88:91], v[16:19], v[52:55]
    ds_read_b128 v[28:31], v116 offset:32768
    s_add_u32 m0, s58, 0
    s_lshl3_add_u32 s63, s82, 14336
    buffer_load_dwordx4 v252, s[24:27], s63 offen offset:2048 lds
    v_mfma_f32_16x16x32_bf16 v[56:59], v[92:95], v[16:19], v[56:59]
    ds_read_b64_tr_b16 v[100:101], v123 offset:32768
    v_mfma_f32_16x16x32_bf16 v[60:63], v[88:91], v[20:23], v[60:63]
    ds_read_b64_tr_b16 v[102:103], v123 offset:33792
    v_mfma_f32_16x16x32_bf16 v[64:67], v[92:95], v[20:23], v[64:67]
    ds_read_b128 v[32:35], v117 offset:32768
    v_mfma_f32_16x16x32_bf16 v[68:71], v[88:91], v[24:27], v[68:71]
    ds_read_b128 v[36:39], v118 offset:32768
    v_mfma_f32_16x16x32_bf16 v[72:75], v[92:95], v[24:27], v[72:75]
    ds_read_b128 v[40:43], v119 offset:32768
    v_mfma_f32_16x16x32_bf16 v[152:155], v[12:15], v[12:15], v[152:155]
    ds_read_b128 v[108:111], v9 offset:2048
    s_lshl3_add_u32 s63, s82, 21504
    buffer_load_dwordx4 v252, s[24:27], s63 offen offset:3072 lds
    v_mfma_f32_16x16x32_bf16 v[148:151], v[128:131], v[12:15], v[148:151]
    v_mfma_f32_16x16x32_bf16 v[76:79], v[104:107], v[12:15], v[76:79]
    s_waitcnt vmcnt(8)
    s_waitcnt lgkmcnt(0)
    s_barrier
    v_xor_b32 v112, 0x10000, v112
    v_xor_b32 v113, 0x10000, v113
    v_xor_b32 v114, 0x10000, v114
    v_xor_b32 v115, 0x10000, v115
    v_xor_b32 v120, 0x10000, v120
    v_xor_b32 v121, 0x10000, v121
    v_mfma_f32_16x16x32_bf16 v[44:47], v[96:99], v[28:31], v[44:47]
    ds_read_b64_tr_b16 v[88:89], v120 offset:0
    v_mfma_f32_16x16x32_bf16 v[48:51], v[100:103], v[28:31], v[48:51]
    ds_read_b64_tr_b16 v[90:91], v120 offset:1024
    v_mfma_f32_16x16x32_bf16 v[52:55], v[96:99], v[32:35], v[52:55]
    ds_read_b128 v[12:15], v112 offset:0
    s_add_u32 m0, s58, 32768
    s_lshl3_add_u32 s63, s83, 0
    buffer_load_dwordx4 v252, s[24:27], s63 offen offset:0 lds
    v_mfma_f32_16x16x32_bf16 v[56:59], v[100:103], v[32:35], v[56:59]
    ds_read_b64_tr_b16 v[92:93], v121 offset:0
    v_mfma_f32_16x16x32_bf16 v[60:63], v[96:99], v[36:39], v[60:63]
    ds_read_b64_tr_b16 v[94:95], v121 offset:1024
    v_mfma_f32_16x16x32_bf16 v[64:67], v[100:103], v[36:39], v[64:67]
    ds_read_b128 v[16:19], v113 offset:0
    v_mfma_f32_16x16x32_bf16 v[68:71], v[96:99], v[40:43], v[68:71]
    ds_read_b128 v[20:23], v114 offset:0
    v_mfma_f32_16x16x32_bf16 v[72:75], v[100:103], v[40:43], v[72:75]
    ds_read_b128 v[24:27], v115 offset:0
    v_mfma_f32_16x16x32_bf16 v[152:155], v[28:31], v[28:31], v[152:155]
    ds_read_b128 v[104:107], v8 offset:4096
    s_lshl3_add_u32 s63, s83, 7168
    buffer_load_dwordx4 v252, s[24:27], s63 offen offset:1024 lds
    v_mfma_f32_16x16x32_bf16 v[148:151], v[128:131], v[28:31], v[148:151]
    v_mfma_f32_16x16x32_bf16 v[76:79], v[108:111], v[28:31], v[76:79]
    v_xor_b32 v116, 0x10000, v116
    v_xor_b32 v117, 0x10000, v117
    v_xor_b32 v118, 0x10000, v118
    v_xor_b32 v119, 0x10000, v119
    v_xor_b32 v122, 0x10000, v122
    v_xor_b32 v123, 0x10000, v123
    s_waitcnt lgkmcnt(0)
    v_mfma_f32_16x16x32_bf16 v[44:47], v[88:91], v[12:15], v[44:47]
    ds_read_b64_tr_b16 v[96:97], v122 offset:0
    v_mfma_f32_16x16x32_bf16 v[48:51], v[92:95], v[12:15], v[48:51]
    ds_read_b64_tr_b16 v[98:99], v122 offset:1024
    v_mfma_f32_16x16x32_bf16 v[52:55], v[88:91], v[16:19], v[52:55]
    ds_read_b128 v[28:31], v116 offset:0
    s_add_u32 m0, s58, 32768
    s_lshl3_add_u32 s63, s83, 14336
    buffer_load_dwordx4 v252, s[24:27], s63 offen offset:2048 lds
    v_mfma_f32_16x16x32_bf16 v[56:59], v[92:95], v[16:19], v[56:59]
    ds_read_b64_tr_b16 v[100:101], v123 offset:0
    v_mfma_f32_16x16x32_bf16 v[60:63], v[88:91], v[20:23], v[60:63]
    ds_read_b64_tr_b16 v[102:103], v123 offset:1024
    v_mfma_f32_16x16x32_bf16 v[64:67], v[92:95], v[20:23], v[64:67]
    ds_read_b128 v[32:35], v117 offset:0
    v_mfma_f32_16x16x32_bf16 v[68:71], v[88:91], v[24:27], v[68:71]
    ds_read_b128 v[36:39], v118 offset:0
    v_mfma_f32_16x16x32_bf16 v[72:75], v[92:95], v[24:27], v[72:75]
    ds_read_b128 v[40:43], v119 offset:0
    v_mfma_f32_16x16x32_bf16 v[152:155], v[12:15], v[12:15], v[152:155]
    ds_read_b128 v[108:111], v9 offset:4096
    s_lshl3_add_u32 s63, s83, 21504
    buffer_load_dwordx4 v252, s[24:27], s63 offen offset:3072 lds
    v_mfma_f32_16x16x32_bf16 v[148:151], v[128:131], v[12:15], v[148:151]
    v_mfma_f32_16x16x32_bf16 v[76:79], v[104:107], v[12:15], v[76:79]
    s_waitcnt vmcnt(9)
    s_waitcnt lgkmcnt(0)
    s_barrier
    v_mfma_f32_16x16x32_bf16 v[44:47], v[96:99], v[28:31], v[44:47]
    ds_read_b64_tr_b16 v[88:89], v120 offset:32768
    s_lshl_b32 s54, s44, 7
    v_mfma_f32_16x16x32_bf16 v[48:51], v[100:103], v[28:31], v[48:51]
    ds_read_b64_tr_b16 v[90:91], v120 offset:33792
    s_add_u32 s54, s54, 151552
    v_mfma_f32_16x16x32_bf16 v[52:55], v[96:99], v[32:35], v[52:55]
    ds_read_b128 v[12:15], v112 offset:32768
    s_add_u32 m0, s58, 65536
    s_lshl3_add_u32 s63, s84, 0
    buffer_load_dwordx4 v252, s[24:27], s63 offen offset:0 lds
    v_lshl_add_u32 v137, v2, 4, s54
    v_mfma_f32_16x16x32_bf16 v[56:59], v[100:103], v[32:35], v[56:59]
    ds_read_b64_tr_b16 v[92:93], v121 offset:32768
    v_and_b32 v139, 31, v0
    v_mfma_f32_16x16x32_bf16 v[60:63], v[96:99], v[36:39], v[60:63]
    ds_read_b64_tr_b16 v[94:95], v121 offset:33792
    v_lshlrev_b32 v139, 4, v139
    v_mfma_f32_16x16x32_bf16 v[64:67], v[100:103], v[36:39], v[64:67]
    ds_read_b128 v[16:19], v113 offset:32768
    v_lshl_add_u32 v136, v3, 9, v139
    v_mfma_f32_16x16x32_bf16 v[68:71], v[96:99], v[40:43], v[68:71]
    ds_read_b128 v[20:23], v114 offset:32768
    v_add_u32 v136, 147456, v136
    v_mfma_f32_16x16x32_bf16 v[72:75], v[100:103], v[40:43], v[72:75]
    ds_read_b128 v[24:27], v115 offset:32768
    v_mfma_f32_16x16x32_bf16 v[152:155], v[28:31], v[28:31], v[152:155]
    ds_read_b128 v[104:107], v8 offset:6144
    s_lshl3_add_u32 s63, s84, 7168
    buffer_load_dwordx4 v252, s[24:27], s63 offen offset:1024 lds
    v_mfma_f32_16x16x32_bf16 v[148:151], v[128:131], v[28:31], v[148:151]
    ds_read_b128 v[140:143], v116 offset:32768
    v_mfma_f32_16x16x32_bf16 v[76:79], v[108:111], v[28:31], v[76:79]
    ds_read_b128 v[144:147], v9 offset:6144
    s_waitcnt lgkmcnt(0)
    v_mfma_f32_16x16x32_bf16 v[152:155], v[12:15], v[12:15], v[152:155]
    ds_read_b64_tr_b16 v[96:97], v122 offset:32768
    ds_read_b64_tr_b16 v[98:99], v122 offset:33792
    v_mfma_f32_16x16x32_bf16 v[152:155], v[140:143], v[140:143], v[152:155]
    ds_read_b64_tr_b16 v[100:101], v123 offset:32768
    ds_read_b64_tr_b16 v[102:103], v123 offset:33792
    s_add_u32 m0, s58, 65536
    s_lshl3_add_u32 s63, s84, 14336
    buffer_load_dwordx4 v252, s[24:27], s63 offen offset:2048 lds
    v_mfma_f32_16x16x32_bf16 v[148:151], v[128:131], v[12:15], v[148:151]
    ds_read_b128 v[32:35], v117 offset:32768
    ds_read_b128 v[36:39], v118 offset:32768
    v_mfma_f32_16x16x32_bf16 v[148:151], v[128:131], v[140:143], v[148:151]
    ds_read_b128 v[40:43], v119 offset:32768
    v_mfma_f32_16x16x32_bf16 v[76:79], v[104:107], v[12:15], v[76:79]
    s_lshl3_add_u32 s63, s84, 21504
    buffer_load_dwordx4 v252, s[24:27], s63 offen offset:3072 lds
    v_mfma_f32_16x16x32_bf16 v[76:79], v[144:147], v[140:143], v[76:79]
    v_mfma_f32_16x16x32_bf16 v[44:47], v[88:91], v[12:15], v[44:47]
    buffer_store_dwordx4 v[236:239], v240, s[12:15], 0 offen offset:1024 sc1
    v_mfma_f32_16x16x32_bf16 v[48:51], v[92:95], v[12:15], v[48:51]
    v_mfma_f32_16x16x32_bf16 v[52:55], v[88:91], v[16:19], v[52:55]
    v_cndmask_b32 v152, v152, v153, s[74:75]
    v_cndmask_b32 v152, v152, v154, s[76:77]
    v_cndmask_b32 v152, v152, v155, s[78:79]
    ds_bpermute_b32 v152, v247, v152
    v_mfma_f32_16x16x32_bf16 v[56:59], v[92:95], v[16:19], v[56:59]
    v_mul_f32 v148, 0x3b000000, v148
    v_xor_b32 v121, 512, v248
    v_xor_b32 v122, 1024, v248
    v_xor_b32 v123, 1536, v248
    v_mfma_f32_16x16x32_bf16 v[60:63], v[88:91], v[20:23], v[60:63]
    v_mfma_f32_16x16x32_bf16 v[64:67], v[92:95], v[20:23], v[64:67]
    s_waitcnt lgkmcnt(0)
    v_mfma_f32_16x16x32_bf16 v[68:71], v[88:91], v[24:27], v[68:71]
    v_mul_f32 v152, 0x3b000000, v152
    v_fma_f32 v152, -v148, v148, v152
    v_max_f32 v152, 0, v152
    v_add_f32 v135, 0x3727c5ac, v152
    v_rsq_f32 v133, v135
    v_mfma_f32_16x16x32_bf16 v[72:75], v[92:95], v[24:27], v[72:75]
    v_fmamk_f32 v135, v135, 0x3727c5ac, v152
    v_rsq_f32 v132, v135
    v_mul_f32 v76, -v76, v133
    v_mul_f32 v77, -v77, v133
    v_mul_f32 v78, v78, v133
    v_mfma_f32_16x16x32_bf16 v[44:47], v[96:99], v[140:143], v[44:47]
    v_mul_f32 v79, v79, v133
    v_mul_f32 v134, -v132, v148
    v_cvt_pk_bf16_f32 v76, v76, v77
    v_cvt_pk_bf16_f32 v77, v78, v79
    ds_write_b128 v248, v[132:135]
    v_mfma_f32_16x16x32_bf16 v[48:51], v[100:103], v[140:143], v[48:51]
    ds_write_b32 v249, v76
    ds_write_b32 v249, v77 offset:512
    s_waitcnt lgkmcnt(0)
    s_barrier
    v_mfma_f32_16x16x32_bf16 v[52:55], v[96:99], v[32:35], v[52:55]
    ds_read_b128 v[76:79], v136
    ds_read_b128 v[140:143], v248
    ds_read_b128 v[144:147], v121
    v_mfma_f32_16x16x32_bf16 v[56:59], v[100:103], v[32:35], v[56:59]
    ds_read_b128 v[148:151], v122
    ds_read_b128 v[152:155], v123
    v_mfma_f32_16x16x32_bf16 v[60:63], v[96:99], v[36:39], v[60:63]
    v_mfma_f32_16x16x32_bf16 v[64:67], v[100:103], v[36:39], v[64:67]
    v_mfma_f32_16x16x32_bf16 v[68:71], v[96:99], v[40:43], v[68:71]
    v_mfma_f32_16x16x32_bf16 v[72:75], v[100:103], v[40:43], v[72:75]
    s_waitcnt lgkmcnt(4)
    s_mov_b32 exec_hi, 0
    buffer_store_dwordx4 v[76:79], v139, s[12:15], s72 offen sc1
    s_mov_b64 exec, -1
    s_waitcnt lgkmcnt(0)
    v_mul_f32 v44, -v44, v141
    v_mul_f32 v45, -v45, v141
    v_mul_f32 v46, v46, v141
    v_mul_f32 v47, v47, v141
    v_mul_f32 v48, -v48, v141
    v_mul_f32 v49, -v49, v141
    v_mul_f32 v50, v50, v141
    v_mul_f32 v51, v51, v141
    v_cvt_pk_bf16_f32 v12, v44, v45
    v_cvt_pk_bf16_f32 v16, v46, v47
    v_cvt_pk_bf16_f32 v20, v48, v49
    v_cvt_pk_bf16_f32 v24, v50, v51
    v_mul_f32 v52, -v52, v145
    v_mul_f32 v53, -v53, v145
    v_mul_f32 v54, v54, v145
    v_mul_f32 v55, v55, v145
    v_mul_f32 v56, -v56, v145
    v_mul_f32 v57, -v57, v145
    v_mul_f32 v58, v58, v145
    v_mul_f32 v59, v59, v145
    v_cvt_pk_bf16_f32 v13, v52, v53
    v_cvt_pk_bf16_f32 v17, v54, v55
    v_cvt_pk_bf16_f32 v21, v56, v57
    v_cvt_pk_bf16_f32 v25, v58, v59
    v_mul_f32 v60, -v60, v149
    v_mul_f32 v61, -v61, v149
    v_mul_f32 v62, v62, v149
    v_mul_f32 v63, v63, v149
    v_mul_f32 v64, -v64, v149
    v_mul_f32 v65, -v65, v149
    v_mul_f32 v66, v66, v149
    v_mul_f32 v67, v67, v149
    v_cvt_pk_bf16_f32 v14, v60, v61
    v_cvt_pk_bf16_f32 v18, v62, v63
    v_cvt_pk_bf16_f32 v22, v64, v65
    v_cvt_pk_bf16_f32 v26, v66, v67
    v_mul_f32 v68, -v68, v153
    v_mul_f32 v69, -v69, v153
    v_mul_f32 v70, v70, v153
    v_mul_f32 v71, v71, v153
    v_mul_f32 v72, -v72, v153
    v_mul_f32 v73, -v73, v153
    v_mul_f32 v74, v74, v153
    v_mul_f32 v75, v75, v153
    v_cvt_pk_bf16_f32 v15, v68, v69
    v_cvt_pk_bf16_f32 v19, v70, v71
    v_cvt_pk_bf16_f32 v23, v72, v73
    v_cvt_pk_bf16_f32 v27, v74, v75
    s_bitcmp1_b32 s49, 0
    s_cbranch_scc0 L_nsw_7
    v_swap_b32 v12, v13
    v_swap_b32 v14, v15
    v_swap_b32 v16, v17
    v_swap_b32 v18, v19
    v_swap_b32 v20, v21
    v_swap_b32 v22, v23
    v_swap_b32 v24, v25
    v_swap_b32 v26, v27
L_nsw_7:
    s_bitcmp1_b32 s49, 1
    s_cbranch_scc0 L_nsw_8
    v_swap_b32 v12, v14
    v_swap_b32 v13, v15
    v_swap_b32 v16, v18
    v_swap_b32 v17, v19
    v_swap_b32 v20, v22
    v_swap_b32 v21, v23
    v_swap_b32 v24, v26
    v_swap_b32 v25, v27
L_nsw_8:
    v_mul_u32_u24 v132, 16896, v2
    v_lshl_add_u32 v132, v1, 4, v132
    s_lshl2_add_u32 s54, s46, s49
    s_add_u32 s52, s54, 8
    s_mul_i32 s52, s52, 135168
    s_add_u32 s52, s52, s66
    s_add_u32 s53, s52, 0
    buffer_store_dwordx4 v[12:15], v132, s[12:15], s53 offen sc1
    s_add_u32 s53, s52, 8448
    buffer_store_dwordx4 v[16:19], v132, s[12:15], s53 offen sc1
    s_add_u32 s53, s52, 67584
    buffer_store_dwordx4 v[20:23], v132, s[12:15], s53 offen sc1
    s_add_u32 s53, s52, 76032
    buffer_store_dwordx4 v[24:27], v132, s[12:15], s53 offen sc1
    s_lshl_b32 s54, s54, 13
    s_lshr_b32 s53, s66, 4
    s_add_u32 s54, s54, s53
    s_add_u32 s54, s54, 14876672
    v_lshl_add_u32 v133, v0, 9, s54
    v_mov_b32 v254, 14684160
    v_lshl_add_u32 v254, s2, 7, v254
    s_waitcnt vmcnt(0)
    s_cmp_eq_u32 s48, 0
    s_cbranch_scc0 L_nd3_9
    s_add_u32 m0, s58, 98304
    s_lshl3_add_u32 s63, s85, 0
    buffer_load_dwordx4 v252, s[24:27], s63 offen offset:0 lds
    s_lshl3_add_u32 s63, s85, 7168
    buffer_load_dwordx4 v252, s[24:27], s63 offen offset:1024 lds
    s_add_u32 m0, s58, 98304
    s_lshl3_add_u32 s63, s85, 14336
    buffer_load_dwordx4 v252, s[24:27], s63 offen offset:2048 lds
    s_lshl3_add_u32 s63, s85, 21504
    buffer_load_dwordx4 v252, s[24:27], s63 offen offset:3072 lds
L_nd3_9:
    s_mov_b64 exec, 65535
    buffer_store_dword v255, v133, s[12:15], 0 offen sc1
    s_mov_b64 exec, -1
    s_mov_b64 exec, 1023
    buffer_store_dword v255, v250, s[12:15], 0 offen sc1
    s_mov_b64 exec, -1
    s_cmp_ge_u32 s44, 4
    s_cbranch_scc1 L_ce_10
    v_lshl_add_u32 v96, v3, 4, v1
    v_cvt_f32_u32 v96, v96
    v_lshlrev_b32 v97, 2, v2
    v_cvt_f32_u32 v97, v97
    v_cvt_f32_u32 v98, v1
    v_and_b32 v102, 1, v1
    v_mul_u32_u24 v102, 0x8000, v102
    v_lshl_or_b32 v102, v102, 16, v102
    v_mul_f32 v99, 0x3c800000, v96
    v_mul_f32 v100, v99, v97
    v_fmamk_f32 v88, v99, 0x00000000, v100
    v_fmamk_f32 v89, v99, 0x3f800000, v100
    v_fmamk_f32 v90, v99, 0x40000000, v100
    v_fmamk_f32 v91, v99, 0x40400000, v100
    v_cos_f32 v92, v88
    v_sin_f32 v88, v88
    v_cos_f32 v93, v89
    v_sin_f32 v89, v89
    v_cos_f32 v94, v90
    v_sin_f32 v90, v90
    v_cos_f32 v95, v91
    v_sin_f32 v91, v91
    v_cvt_pk_bf16_f32 v156, v92, v88
    v_cvt_pk_bf16_f32 v172, -v88, v92
    v_cvt_pk_bf16_f32 v157, v93, v89
    v_cvt_pk_bf16_f32 v173, -v89, v93
    v_cvt_pk_bf16_f32 v158, v94, v90
    v_cvt_pk_bf16_f32 v174, -v90, v94
    v_cvt_pk_bf16_f32 v159, v95, v91
    v_cvt_pk_bf16_f32 v175, -v91, v95
    v_fmamk_f32 v88, v99, 0x41800000, v100
    v_fmamk_f32 v89, v99, 0x41880000, v100
    v_fmamk_f32 v90, v99, 0x41900000, v100
    v_fmamk_f32 v91, v99, 0x41980000, v100
    v_cos_f32 v92, v88
    v_sin_f32 v88, v88
    v_cos_f32 v93, v89
    v_sin_f32 v89, v89
    v_cos_f32 v94, v90
    v_sin_f32 v90, v90
    v_cos_f32 v95, v91
    v_sin_f32 v91, v91
    v_cvt_pk_bf16_f32 v160, v92, v88
    v_cvt_pk_bf16_f32 v176, -v88, v92
    v_cvt_pk_bf16_f32 v161, v93, v89
    v_cvt_pk_bf16_f32 v177, -v89, v93
    v_cvt_pk_bf16_f32 v162, v94, v90
    v_cvt_pk_bf16_f32 v178, -v90, v94
    v_cvt_pk_bf16_f32 v163, v95, v91
    v_cvt_pk_bf16_f32 v179, -v91, v95
    v_xor_b32 v164, v102, v156
    v_xor_b32 v165, v102, v157
    v_xor_b32 v166, v102, v158
    v_xor_b32 v167, v102, v159
    v_xor_b32 v168, v102, v160
    v_xor_b32 v169, v102, v161
    v_xor_b32 v170, v102, v162
    v_xor_b32 v171, v102, v163
    v_xor_b32 v180, v102, v172
    v_xor_b32 v181, v102, v173
    v_xor_b32 v182, v102, v174
    v_xor_b32 v183, v102, v175
    v_xor_b32 v184, v102, v176
    v_xor_b32 v185, v102, v177
    v_xor_b32 v186, v102, v178
    v_xor_b32 v187, v102, v179
    v_mul_f32 v99, 0x3a000000, v96
    v_mul_f32 v100, v99, v97
    v_fmamk_f32 v196, v99, 0x00000000, v100
    v_fmamk_f32 v197, v99, 0x3f800000, v100
    v_fmamk_f32 v198, v99, 0x40000000, v100
    v_fmamk_f32 v199, v99, 0x40400000, v100
    v_fmamk_f32 v200, v99, 0x41800000, v100
    v_fmamk_f32 v201, v99, 0x41880000, v100
    v_fmamk_f32 v202, v99, 0x41900000, v100
    v_fmamk_f32 v203, v99, 0x41980000, v100
    v_cos_f32 v188, v196
    v_sin_f32 v196, v196
    v_cos_f32 v189, v197
    v_sin_f32 v197, v197
    v_cos_f32 v190, v198
    v_sin_f32 v198, v198
    v_cos_f32 v191, v199
    v_sin_f32 v199, v199
    v_cos_f32 v192, v200
    v_sin_f32 v200, v200
    v_cos_f32 v193, v201
    v_sin_f32 v201, v201
    v_cos_f32 v194, v202
    v_sin_f32 v202, v202
    v_cos_f32 v195, v203
    v_sin_f32 v203, v203
    v_mul_f32 v99, 0x3d000000, v98
    v_mul_f32 v100, v99, v97
    v_fmamk_f32 v88, v99, 0x00000000, v100
    v_fmamk_f32 v89, v99, 0x3f800000, v100
    v_fmamk_f32 v90, v99, 0x40000000, v100
    v_fmamk_f32 v91, v99, 0x40400000, v100
    v_cos_f32 v92, v88
    v_sin_f32 v88, v88
    v_cos_f32 v93, v89
    v_sin_f32 v89, v89
    v_cos_f32 v94, v90
    v_sin_f32 v90, v90
    v_cos_f32 v95, v91
    v_sin_f32 v91, v91
    v_cvt_pk_bf16_f32 v220, v92, v88
    v_cvt_pk_bf16_f32 v224, -v88, v92
    v_mov_b32 v228, v220
    v_mov_b32 v232, v224
    v_cvt_pk_bf16_f32 v221, v93, v89
    v_cvt_pk_bf16_f32 v225, -v89, v93
    v_xor_b32 v229, 0x80008000, v221
    v_xor_b32 v233, 0x80008000, v225
    v_cvt_pk_bf16_f32 v222, v94, v90
    v_cvt_pk_bf16_f32 v226, -v90, v94
    v_mov_b32 v230, v222
    v_mov_b32 v234, v226
    v_cvt_pk_bf16_f32 v223, v95, v91
    v_cvt_pk_bf16_f32 v227, -v91, v95
    v_xor_b32 v231, 0x80008000, v223
    v_xor_b32 v235, 0x80008000, v227
    v_lshlrev_b32 v101, 4, v3
    v_cvt_f32_u32 v101, v101
    v_add_f32 v101, v101, v97
    s_cmp_eq_u32 s2, 255
    s_mov_b32 s52, 0x36000000
    s_cselect_b32 s52, 0x35800000, s52
    v_add_f32 v99, 0x00000000, v98
    v_mul_f32 v99, 0x3a000000, v99
    v_mul_f32 v100, v99, v101
    v_fmamk_f32 v212, v99, 0x00000000, v100
    v_fmamk_f32 v213, v99, 0x3f800000, v100
    v_fmamk_f32 v214, v99, 0x40000000, v100
    v_fmamk_f32 v215, v99, 0x40400000, v100
    v_add_f32 v99, 0x41800000, v98
    v_mul_f32 v99, 0x3a000000, v99
    v_mul_f32 v100, v99, v101
    v_fmamk_f32 v216, v99, 0x00000000, v100
    v_fmamk_f32 v217, v99, 0x3f800000, v100
    v_fmamk_f32 v218, v99, 0x40000000, v100
    v_fmamk_f32 v219, v99, 0x40400000, v100
    v_cos_f32 v204, v212
    v_sin_f32 v212, v212
    v_cos_f32 v205, v213
    v_sin_f32 v213, v213
    v_cos_f32 v206, v214
    v_sin_f32 v214, v214
    v_cos_f32 v207, v215
    v_sin_f32 v215, v215
    v_cos_f32 v208, v216
    v_sin_f32 v216, v216
    v_cos_f32 v209, v217
    v_sin_f32 v217, v217
    v_cos_f32 v210, v218
    v_sin_f32 v218, v218
    v_cos_f32 v211, v219
    v_sin_f32 v219, v219
    v_mul_f32 v204, s52, v204
    v_mul_f32 v205, s52, v205
    v_mul_f32 v206, s52, v206
    v_mul_f32 v207, s52, v207
    v_mul_f32 v208, s52, v208
    v_mul_f32 v209, s52, v209
    v_mul_f32 v210, s52, v210
    v_mul_f32 v211, s52, v211
    v_mul_f32 v212, s52, v212
    v_mul_f32 v213, s52, v213
    v_mul_f32 v214, s52, v214
    v_mul_f32 v215, s52, v215
    v_mul_f32 v216, s52, v216
    v_mul_f32 v217, s52, v217
    v_mul_f32 v218, s52, v218
    v_mul_f32 v219, s52, v219
L_ce_10:
L_p1done_2:
    s_cmp_ge_u32 s44, 4
    s_cbranch_scc1 L_bwave_11
    s_lshl2_add_u32 s52, s2, s44
    s_lshl_b32 s52, s52, 7
    s_add_u32 s53, s52, 14942208
    s_add_u32 s52, s52, 14811136
    v_lshl_add_u32 v148, v1, 3, s53
    v_and_b32 v149, 7, v0
    v_lshl_add_u32 v149, v149, 4, s52
    v_cmp_gt_u32 vcc, 16, v0
    s_nop 1
    v_cndmask_b32 v7, v149, v148, vcc
    v_lshlrev_b32 v4, 9, v2
    v_lshl_add_u32 v4, v1, 4, v4
    v_lshlrev_b32 v150, 4, v0
    v_lshl_add_u32 v5, v3, 10, v150
    v_lshl_add_u32 v151, v3, 11, v150
    v_add_u32 v6, 131072, v4
    s_waitcnt vmcnt(0)
    s_mov_b64 exec, 255
    buffer_store_dword v255, v254, s[12:15], 0 offen sc1
    s_mov_b64 exec, -1
    v_mov_b32 v10, 152604
    v_mov_b32 v11, 1
    s_mov_b64 exec, 1
    ds_add_u32 v10, v11
    s_mov_b64 exec, -1
    s_bitcmp1_b32 s49, 0
    s_cbranch_scc0 L_nsw_14
    v_swap_b32 v28, v32
    v_swap_b32 v29, v33
    v_swap_b32 v30, v34
    v_swap_b32 v31, v35
    v_swap_b32 v36, v40
    v_swap_b32 v37, v41
    v_swap_b32 v38, v42
    v_swap_b32 v39, v43
L_nsw_14:
    s_bitcmp1_b32 s49, 1
    s_cbranch_scc0 L_nsw_15
    v_swap_b32 v28, v36
    v_swap_b32 v29, v37
    v_swap_b32 v30, v38
    v_swap_b32 v31, v39
    v_swap_b32 v32, v40
    v_swap_b32 v33, v41
    v_swap_b32 v34, v42
    v_swap_b32 v35, v43
L_nsw_15:
    v_lshl_add_u32 v100, s65, 6, v1
    v_cvt_f32_u32 v100, v100
    v_mul_f32 v100, 0x3b000000, v100
    v_lshl_add_u32 v101, s49, 3, v2
    v_lshl_add_u32 v101, v101, 2, 1
    v_cvt_f32_u32 v101, v101
    v_add_f32 v102, 0x00000000, v100
    v_mul_f32 v103, v102, v101
    v_fmamk_f32 v92, v102, 0x00000000, v103
    v_fmamk_f32 v93, v102, 0x3f800000, v103
    v_fmamk_f32 v94, v102, 0x40000000, v103
    v_fmamk_f32 v95, v102, 0x40400000, v103
    v_cos_f32 v96, v92
    v_sin_f32 v92, v92
    v_cos_f32 v97, v93
    v_sin_f32 v93, v93
    v_cos_f32 v98, v94
    v_sin_f32 v94, v94
    v_cos_f32 v99, v95
    v_sin_f32 v95, v95
    v_cvt_pk_bf16_f32 v12, v96, -v92
    v_cvt_pk_bf16_f32 v13, v97, -v93
    v_cvt_pk_bf16_f32 v14, v98, -v94
    v_cvt_pk_bf16_f32 v15, v99, -v95
    v_fmamk_f32 v92, v102, 0x41800000, v103
    v_fmamk_f32 v93, v102, 0x41880000, v103
    v_fmamk_f32 v94, v102, 0x41900000, v103
    v_fmamk_f32 v95, v102, 0x41980000, v103
    v_cos_f32 v96, v92
    v_sin_f32 v92, v92
    v_cos_f32 v97, v93
    v_sin_f32 v93, v93
    v_cos_f32 v98, v94
    v_sin_f32 v94, v94
    v_cos_f32 v99, v95
    v_sin_f32 v95, v95
    v_cvt_pk_bf16_f32 v44, v96, -v92
    v_cvt_pk_bf16_f32 v45, v97, -v93
    v_cvt_pk_bf16_f32 v46, v98, -v94
    v_cvt_pk_bf16_f32 v47, v99, -v95
    v_add_f32 v102, 0x3d000000, v100
    v_mul_f32 v103, v102, v101
    v_fmamk_f32 v92, v102, 0x00000000, v103
    v_fmamk_f32 v93, v102, 0x3f800000, v103
    v_fmamk_f32 v94, v102, 0x40000000, v103
    v_fmamk_f32 v95, v102, 0x40400000, v103
    v_cos_f32 v96, v92
    v_sin_f32 v92, v92
    v_cos_f32 v97, v93
    v_sin_f32 v93, v93
    v_cos_f32 v98, v94
    v_sin_f32 v94, v94
    v_cos_f32 v99, v95
    v_sin_f32 v95, v95
    v_cvt_pk_bf16_f32 v16, v96, -v92
    v_cvt_pk_bf16_f32 v17, v97, -v93
    v_cvt_pk_bf16_f32 v18, v98, -v94
    v_cvt_pk_bf16_f32 v19, v99, -v95
    v_fmamk_f32 v92, v102, 0x41800000, v103
    v_fmamk_f32 v93, v102, 0x41880000, v103
    v_fmamk_f32 v94, v102, 0x41900000, v103
    v_fmamk_f32 v95, v102, 0x41980000, v103
    v_cos_f32 v96, v92
    v_sin_f32 v92, v92
    v_cos_f32 v97, v93
    v_sin_f32 v93, v93
    v_cos_f32 v98, v94
    v_sin_f32 v94, v94
    v_cos_f32 v99, v95
    v_sin_f32 v95, v95
    v_cvt_pk_bf16_f32 v48, v96, -v92
    v_cvt_pk_bf16_f32 v49, v97, -v93
    v_cvt_pk_bf16_f32 v50, v98, -v94
    v_cvt_pk_bf16_f32 v51, v99, -v95
    v_add_f32 v102, 0x3d800000, v100
    v_mul_f32 v103, v102, v101
    v_fmamk_f32 v92, v102, 0x00000000, v103
    v_fmamk_f32 v93, v102, 0x3f800000, v103
    v_fmamk_f32 v94, v102, 0x40000000, v103
    v_fmamk_f32 v95, v102, 0x40400000, v103
    v_cos_f32 v96, v92
    v_sin_f32 v92, v92
    v_cos_f32 v97, v93
    v_sin_f32 v93, v93
    v_cos_f32 v98, v94
    v_sin_f32 v94, v94
    v_cos_f32 v99, v95
    v_sin_f32 v95, v95
    v_cvt_pk_bf16_f32 v20, v96, -v92
    v_cvt_pk_bf16_f32 v21, v97, -v93
    v_cvt_pk_bf16_f32 v22, v98, -v94
    v_cvt_pk_bf16_f32 v23, v99, -v95
    v_fmamk_f32 v92, v102, 0x41800000, v103
    v_fmamk_f32 v93, v102, 0x41880000, v103
    v_fmamk_f32 v94, v102, 0x41900000, v103
    v_fmamk_f32 v95, v102, 0x41980000, v103
    v_cos_f32 v96, v92
    v_sin_f32 v92, v92
    v_cos_f32 v97, v93
    v_sin_f32 v93, v93
    v_cos_f32 v98, v94
    v_sin_f32 v94, v94
    v_cos_f32 v99, v95
    v_sin_f32 v95, v95
    v_cvt_pk_bf16_f32 v52, v96, -v92
    v_cvt_pk_bf16_f32 v53, v97, -v93
    v_cvt_pk_bf16_f32 v54, v98, -v94
    v_cvt_pk_bf16_f32 v55, v99, -v95
    buffer_load_dword v8, v7, s[12:15], 0 offen sc1
    v_add_f32 v102, 0x3dc00000, v100
    v_mul_f32 v103, v102, v101
    v_fmamk_f32 v92, v102, 0x00000000, v103
    v_fmamk_f32 v93, v102, 0x3f800000, v103
    v_fmamk_f32 v94, v102, 0x40000000, v103
    v_fmamk_f32 v95, v102, 0x40400000, v103
    v_cos_f32 v96, v92
    v_sin_f32 v92, v92
    v_cos_f32 v97, v93
    v_sin_f32 v93, v93
    v_cos_f32 v98, v94
    v_sin_f32 v94, v94
    v_cos_f32 v99, v95
    v_sin_f32 v95, v95
    v_cvt_pk_bf16_f32 v24, v96, -v92
    v_cvt_pk_bf16_f32 v25, v97, -v93
    v_cvt_pk_bf16_f32 v26, v98, -v94
    v_cvt_pk_bf16_f32 v27, v99, -v95
    v_fmamk_f32 v92, v102, 0x41800000, v103
    v_fmamk_f32 v93, v102, 0x41880000, v103
    v_fmamk_f32 v94, v102, 0x41900000, v103
    v_fmamk_f32 v95, v102, 0x41980000, v103
    v_cos_f32 v96, v92
    v_sin_f32 v92, v92
    v_cos_f32 v97, v93
    v_sin_f32 v93, v93
    v_cos_f32 v98, v94
    v_sin_f32 v94, v94
    v_cos_f32 v99, v95
    v_sin_f32 v95, v95
    v_cvt_pk_bf16_f32 v56, v96, -v92
    v_cvt_pk_bf16_f32 v57, v97, -v93
    v_cvt_pk_bf16_f32 v58, v98, -v94
    v_cvt_pk_bf16_f32 v59, v99, -v95
    s_setprio 3
    s_waitcnt vmcnt(0)
    v_mov_b32 v10, 152612
    v_mov_b32 v11, 1
    s_mov_b64 exec, 1
    ds_add_u32 v10, v11
    s_mov_b64 exec, -1
    s_mov_b32 s61, 0x40000
L_poll_16:
    v_cmp_ne_u32 vcc, v255, v8
    s_nop 0
    s_cmp_eq_u64 vcc, 0
    s_cbranch_scc1 L_polled_17
    s_sleep 10
    buffer_load_dword v8, v7, s[12:15], 0 offen sc1
    s_waitcnt vmcnt(0)
    s_sub_u32 s61, s61, 1
    s_cbranch_scc0 L_poll_16
L_polled_17:
    s_mul_i32 s53, s2, 8448
    s_lshr_b32 s52, s58, 1
    s_add_u32 m0, s52, 131072
    s_nop 0
    buffer_load_dwordx4 v151, s[12:15], s53 offen offset:0 sc1 lds
    buffer_load_dwordx4 v151, s[12:15], s53 offen offset:1024 sc1 lds
    s_add_u32 s53, s53, 4718592
    s_add_u32 s54, s53, 4096
    buffer_load_dwordx4 v[60:63], v5, s[12:15], s53 offen sc1
    buffer_load_dwordx4 v[64:67], v5, s[12:15], s54 offen sc1
    v_add_u32 v5, 155648, v5
    v_and_b32 v148, 1, v1
    v_mul_u32_u24 v148, 0x8000, v148
    v_lshl_or_b32 v148, v148, 16, v148
    v_xor_b32 v76, v148, v220
    v_xor_b32 v77, v148, v221
    v_xor_b32 v78, v148, v222
    v_xor_b32 v79, v148, v223
    v_xor_b32 v80, v148, v224
    v_xor_b32 v81, v148, v225
    v_xor_b32 v82, v148, v226
    v_xor_b32 v83, v148, v227
    v_xor_b32 v84, v148, v228
    v_xor_b32 v85, v148, v229
    v_xor_b32 v86, v148, v230
    v_xor_b32 v87, v148, v231
    v_xor_b32 v88, v148, v232
    v_xor_b32 v89, v148, v233
    v_xor_b32 v90, v148, v234
    v_xor_b32 v91, v148, v235
    v_lshrrev_b32 v68, 2, v1
    v_lshl_add_u32 v68, v2, 2, v68
    v_bfe_u32 v69, v68, 1, 2
    v_lshlrev_b32 v69, 5, v69
    v_lshl_add_u32 v68, v68, 7, v69
    v_and_b32 v69, 3, v1
    v_lshl_add_u32 v68, v69, 3, v68
    v_lshl_add_u32 v244, s49, 12, v68
    v_xor_b32 v245, 32, v244
    v_xor_b32 v246, 64, v244
    v_xor_b32 v247, 96, v244
    s_xor_b32 s52, s62, s48
    s_lshl1_add_u32 s52, s52, s46
    s_mul_i32 s52, s52, 28
    s_add_u32 s52, s52, s49
    s_lshl_b32 s52, s52, 12
    s_add_u32 s52, s52, 7077888
    v_lshl_add_u32 v248, v0, 4, s52
    s_lshr_b32 s52, s62, 1
    s_lshr_b32 s53, s44, 1
    s_lshl2_add_u32 s52, s52, s53
    s_and_b32 s53, s62, 1
    s_lshl1_add_u32 s52, s52, s53
    s_and_b32 s53, s44, 1
    s_lshl1_add_u32 s52, s52, s53
    v_lshrrev_b32 v68, 3, v0
    v_lshl_add_u32 v68, s52, 3, v68
    v_and_b32 v69, 7, v0
    v_lshlrev_b32 v69, 4, v69
    v_lshl_add_u32 v251, s65, 7, v69
    v_lshl_add_u32 v250, v68, 10, v251
    s_mov_b32 s30, 1024
    s_mov_b32 s31, 0x20000
    s_mov_b32 s34, 2097152
    s_mov_b32 s35, 0x20000
    s_waitcnt vmcnt(2)
    v_mov_b32 v8, 152580
    v_mov_b32 v9, 1
    s_mov_b64 exec, 1
    ds_add_u32 v8, v9
    s_mov_b64 exec, -1
    v_mov_b32 v8, 152580
L_lw_18:
    ds_read_b32 v9, v8
    s_waitcnt lgkmcnt(0)
    v_cmp_ne_u32 vcc, 4, v9
    s_nop 0
    s_cmp_eq_u64 vcc, 0
    s_cbranch_scc1 L_lwd_19
    s_branch L_lw_18
L_lwd_19:
    ds_read_b128 v[92:95], v6 offset:0
    ds_read_b128 v[108:111], v6 offset:256
    ds_read_b128 v[96:99], v6 offset:2048
    ds_read_b128 v[112:115], v6 offset:2304
    ds_read_b128 v[100:103], v6 offset:4096
    ds_read_b128 v[116:119], v6 offset:4352
    ds_read_b128 v[104:107], v6 offset:6144
    ds_read_b128 v[120:123], v6 offset:6400
    s_waitcnt lgkmcnt(6)
    v_mfma_f32_16x16x32_bf16 v[124:127], v[92:95], v[156:159], 0
    v_mfma_f32_16x16x32_bf16 v[128:131], v[92:95], v[172:175], 0
    v_mfma_f32_16x16x32_bf16 v[132:135], v[108:111], v[156:159], 0
    v_mfma_f32_16x16x32_bf16 v[136:139], v[108:111], v[172:175], 0
    s_waitcnt lgkmcnt(4)
    v_mfma_f32_16x16x32_bf16 v[124:127], v[96:99], v[160:163], v[124:127]
    v_mfma_f32_16x16x32_bf16 v[128:131], v[96:99], v[176:179], v[128:131]
    v_mfma_f32_16x16x32_bf16 v[132:135], v[112:115], v[160:163], v[132:135]
    v_mfma_f32_16x16x32_bf16 v[136:139], v[112:115], v[176:179], v[136:139]
    s_waitcnt lgkmcnt(2)
    v_mfma_f32_16x16x32_bf16 v[124:127], v[100:103], v[164:167], v[124:127]
    v_mfma_f32_16x16x32_bf16 v[128:131], v[100:103], v[180:183], v[128:131]
    v_mfma_f32_16x16x32_bf16 v[132:135], v[116:119], v[164:167], v[132:135]
    v_mfma_f32_16x16x32_bf16 v[136:139], v[116:119], v[180:183], v[136:139]
    s_waitcnt lgkmcnt(0)
    v_mfma_f32_16x16x32_bf16 v[124:127], v[104:107], v[168:171], v[124:127]
    v_mfma_f32_16x16x32_bf16 v[128:131], v[104:107], v[184:187], v[128:131]
    v_mfma_f32_16x16x32_bf16 v[132:135], v[120:123], v[168:171], v[132:135]
    v_mfma_f32_16x16x32_bf16 v[136:139], v[120:123], v[184:187], v[136:139]
    s_nop 4
    v_mul_f32 v148, v124, v188
    v_mul_f32 v152, v128, v188
    v_mul_f32 v149, v125, v189
    v_mul_f32 v153, v129, v189
    v_mul_f32 v150, v126, v190
    v_mul_f32 v154, v130, v190
    v_mul_f32 v151, v127, v191
    v_mul_f32 v155, v131, v191
    v_fma_f32 v148, v128, v196, v148
    v_fma_f32 v152, -v124, v196, v152
    v_fma_f32 v149, v129, v197, v149
    v_fma_f32 v153, -v125, v197, v153
    v_fma_f32 v150, v130, v198, v150
    v_fma_f32 v154, -v126, v198, v154
    v_fma_f32 v151, v131, v199, v151
    v_fma_f32 v155, -v127, v199, v155
    v_cvt_pk_bf16_f32 v140, v148, v152
    v_cvt_pk_bf16_f32 v141, v149, v153
    v_cvt_pk_bf16_f32 v142, v150, v154
    v_cvt_pk_bf16_f32 v143, v151, v155
    v_mul_f32 v148, v132, v192
    v_mul_f32 v152, v136, v192
    v_mul_f32 v149, v133, v193
    v_mul_f32 v153, v137, v193
    v_mul_f32 v150, v134, v194
    v_mul_f32 v154, v138, v194
    v_mul_f32 v151, v135, v195
    v_mul_f32 v155, v139, v195
    v_fma_f32 v148, v136, v200, v148
    v_fma_f32 v152, -v132, v200, v152
    v_fma_f32 v149, v137, v201, v149
    v_fma_f32 v153, -v133, v201, v153
    v_fma_f32 v150, v138, v202, v150
    v_fma_f32 v154, -v134, v202, v154
    v_fma_f32 v151, v139, v203, v151
    v_fma_f32 v155, -v135, v203, v155
    v_cvt_pk_bf16_f32 v144, v148, v152
    v_cvt_pk_bf16_f32 v145, v149, v153
    v_cvt_pk_bf16_f32 v146, v150, v154
    v_cvt_pk_bf16_f32 v147, v151, v155
    v_mfma_f32_16x16x32_bf16 v[124:127], v[220:223], v[140:143], 0
    v_mfma_f32_16x16x32_bf16 v[128:131], v[224:227], v[140:143], 0
    v_mfma_f32_16x16x32_bf16 v[132:135], v[228:231], v[140:143], 0
    v_mfma_f32_16x16x32_bf16 v[136:139], v[232:235], v[140:143], 0
    v_mfma_f32_16x16x32_bf16 v[124:127], v[76:79], v[144:147], v[124:127]
    v_mfma_f32_16x16x32_bf16 v[128:131], v[80:83], v[144:147], v[128:131]
    v_mfma_f32_16x16x32_bf16 v[132:135], v[84:87], v[144:147], v[132:135]
    v_mfma_f32_16x16x32_bf16 v[136:139], v[88:91], v[144:147], v[136:139]
    v_lshlrev_b32 v6, 4, v0
    v_add_u32 v6, 155648, v6
    s_waitcnt vmcnt(0)
    v_lshlrev_b32 v92, 16, v60
    v_and_b32 v100, 0xffff0000, v60
    v_lshlrev_b32 v93, 16, v61
    v_and_b32 v101, 0xffff0000, v61
    v_lshlrev_b32 v94, 16, v62
    v_and_b32 v102, 0xffff0000, v62
    v_lshlrev_b32 v95, 16, v63
    v_and_b32 v103, 0xffff0000, v63
    v_lshlrev_b32 v96, 16, v64
    v_and_b32 v104, 0xffff0000, v64
    v_lshlrev_b32 v97, 16, v65
    v_and_b32 v105, 0xffff0000, v65
    v_lshlrev_b32 v98, 16, v66
    v_and_b32 v106, 0xffff0000, v66
    v_lshlrev_b32 v99, 16, v67
    v_and_b32 v107, 0xffff0000, v67
    v_mul_f32 v148, v124, v92
    v_mul_f32 v152, v128, v92
    v_mul_f32 v149, v125, v93
    v_mul_f32 v153, v129, v93
    v_mul_f32 v150, v126, v94
    v_mul_f32 v154, v130, v94
    v_mul_f32 v151, v127, v95
    v_mul_f32 v155, v131, v95
    v_fma_f32 v148, -v128, v100, v148
    v_fma_f32 v152, v124, v100, v152
    v_fma_f32 v149, -v129, v101, v149
    v_fma_f32 v153, v125, v101, v153
    v_fma_f32 v150, -v130, v102, v150
    v_fma_f32 v154, v126, v102, v154
    v_fma_f32 v151, -v131, v103, v151
    v_fma_f32 v155, v127, v103, v155
    v_cvt_pk_bf16_f32 v140, v148, -v152
    v_cvt_pk_bf16_f32 v141, v149, -v153
    v_cvt_pk_bf16_f32 v142, v150, -v154
    v_cvt_pk_bf16_f32 v143, v151, -v155
    v_mul_f32 v148, v132, v96
    v_mul_f32 v152, v136, v96
    v_mul_f32 v149, v133, v97
    v_mul_f32 v153, v137, v97
    v_mul_f32 v150, v134, v98
    v_mul_f32 v154, v138, v98
    v_mul_f32 v151, v135, v99
    v_mul_f32 v155, v139, v99
    v_fma_f32 v148, -v136, v104, v148
    v_fma_f32 v152, v132, v104, v152
    v_fma_f32 v149, -v137, v105, v149
    v_fma_f32 v153, v133, v105, v153
    v_fma_f32 v150, -v138, v106, v150
    v_fma_f32 v154, v134, v106, v154
    v_fma_f32 v151, -v139, v107, v151
    v_fma_f32 v155, v135, v107, v155
    v_cvt_pk_bf16_f32 v144, v148, -v152
    v_cvt_pk_bf16_f32 v145, v149, -v153
    v_cvt_pk_bf16_f32 v146, v150, -v154
    v_cvt_pk_bf16_f32 v147, v151, -v155
    v_mfma_f32_16x16x32_bf16 v[124:127], v[140:143], v[220:223], 0
    v_mfma_f32_16x16x32_bf16 v[128:131], v[140:143], v[224:227], 0
    v_mfma_f32_16x16x32_bf16 v[132:135], v[140:143], v[228:231], 0
    v_mfma_f32_16x16x32_bf16 v[136:139], v[140:143], v[232:235], 0
    v_mfma_f32_16x16x32_bf16 v[124:127], v[144:147], v[76:79], v[124:127]
    v_mfma_f32_16x16x32_bf16 v[128:131], v[144:147], v[80:83], v[128:131]
    v_mfma_f32_16x16x32_bf16 v[132:135], v[144:147], v[84:87], v[132:135]
    v_mfma_f32_16x16x32_bf16 v[136:139], v[144:147], v[88:91], v[136:139]
    v_lshl_add_u32 v7, v3, 11, v4
    s_mul_i32 s53, s2, 8448
    s_add_u32 s53, s53, 2359296
    s_nop 1
    v_mul_f32 v148, v124, v204
    v_mul_f32 v152, v128, v204
    v_mul_f32 v149, v125, v205
    v_mul_f32 v153, v129, v205
    v_mul_f32 v150, v126, v206
    v_mul_f32 v154, v130, v206
    v_mul_f32 v151, v127, v207
    v_mul_f32 v155, v131, v207
    v_fma_f32 v148, v128, v212, v148
    v_fma_f32 v152, -v124, v212, v152
    v_fma_f32 v149, v129, v213, v149
    v_fma_f32 v153, -v125, v213, v153
    v_fma_f32 v150, v130, v214, v150
    v_fma_f32 v154, -v126, v214, v154
    v_fma_f32 v151, v131, v215, v151
    v_fma_f32 v155, -v127, v215, v155
    v_cvt_pk_bf16_f32 v140, v148, v152
    v_cvt_pk_bf16_f32 v141, v149, v153
    v_cvt_pk_bf16_f32 v142, v150, v154
    v_cvt_pk_bf16_f32 v143, v151, v155
    v_mul_f32 v148, v132, v208
    v_mul_f32 v152, v136, v208
    v_mul_f32 v149, v133, v209
    v_mul_f32 v153, v137, v209
    v_mul_f32 v150, v134, v210
    v_mul_f32 v154, v138, v210
    v_mul_f32 v151, v135, v211
    v_mul_f32 v155, v139, v211
    v_fma_f32 v148, v136, v216, v148
    v_fma_f32 v152, -v132, v216, v152
    v_fma_f32 v149, v137, v217, v149
    v_fma_f32 v153, -v133, v217, v153
    v_fma_f32 v150, v138, v218, v150
    v_fma_f32 v154, -v134, v218, v154
    v_fma_f32 v151, v139, v219, v151
    v_fma_f32 v155, -v135, v219, v155
    v_cvt_pk_bf16_f32 v144, v148, v152
    v_cvt_pk_bf16_f32 v145, v149, v153
    v_cvt_pk_bf16_f32 v146, v150, v154
    v_cvt_pk_bf16_f32 v147, v151, v155
    ds_write_b128 v5, v[140:143] offset:0
    ds_write_b128 v5, v[144:147] offset:4096
    s_waitcnt lgkmcnt(0)
    v_mov_b32 v10, 152576
    v_mov_b32 v11, 1
    s_mov_b64 exec, 1
    ds_add_u32 v10, v11
    s_mov_b64 exec, -1
    v_mov_b32 v10, 152576
L_lw_20:
    ds_read_b32 v11, v10
    s_waitcnt lgkmcnt(0)
    v_cmp_ne_u32 vcc, 4, v11
    s_nop 0
    s_cmp_eq_u64 vcc, 0
    s_cbranch_scc1 L_lwd_21
    s_branch L_lw_20
L_lwd_21:
    ds_read_b128 v[92:95], v6 offset:0
    ds_read_b128 v[108:111], v6 offset:4096
    ds_read_b128 v[96:99], v6 offset:1024
    ds_read_b128 v[112:115], v6 offset:5120
    ds_read_b128 v[100:103], v6 offset:2048
    ds_read_b128 v[116:119], v6 offset:6144
    ds_read_b128 v[104:107], v6 offset:3072
    ds_read_b128 v[120:123], v6 offset:7168
    s_waitcnt lgkmcnt(6)
    v_mfma_f32_16x16x32_bf16 v[124:127], v[156:159], v[92:95], 0
    v_mfma_f32_16x16x32_bf16 v[128:131], v[172:175], v[92:95], 0
    v_mfma_f32_16x16x32_bf16 v[132:135], v[156:159], v[108:111], 0
    v_mfma_f32_16x16x32_bf16 v[136:139], v[172:175], v[108:111], 0
    s_waitcnt lgkmcnt(4)
    v_mfma_f32_16x16x32_bf16 v[124:127], v[160:163], v[96:99], v[124:127]
    v_mfma_f32_16x16x32_bf16 v[128:131], v[176:179], v[96:99], v[128:131]
    v_mfma_f32_16x16x32_bf16 v[132:135], v[160:163], v[112:115], v[132:135]
    v_mfma_f32_16x16x32_bf16 v[136:139], v[176:179], v[112:115], v[136:139]
    s_waitcnt lgkmcnt(2)
    v_mfma_f32_16x16x32_bf16 v[124:127], v[164:167], v[100:103], v[124:127]
    v_mfma_f32_16x16x32_bf16 v[128:131], v[180:183], v[100:103], v[128:131]
    v_mfma_f32_16x16x32_bf16 v[132:135], v[164:167], v[116:119], v[132:135]
    v_mfma_f32_16x16x32_bf16 v[136:139], v[180:183], v[116:119], v[136:139]
    s_waitcnt lgkmcnt(0)
    v_mfma_f32_16x16x32_bf16 v[124:127], v[168:171], v[104:107], v[124:127]
    v_mfma_f32_16x16x32_bf16 v[128:131], v[184:187], v[104:107], v[128:131]
    v_mfma_f32_16x16x32_bf16 v[132:135], v[168:171], v[120:123], v[132:135]
    v_mfma_f32_16x16x32_bf16 v[136:139], v[184:187], v[120:123], v[136:139]
    s_nop 5
    v_cvt_pk_bf16_f32 v236, v124, -v128
    v_cvt_pk_bf16_f32 v237, v125, -v129
    v_cvt_pk_bf16_f32 v238, v126, -v130
    v_cvt_pk_bf16_f32 v239, v127, -v131
    buffer_store_dwordx4 v[236:239], v7, s[12:15], s53 offen offset:0 sc1
    v_cvt_pk_bf16_f32 v240, v132, -v136
    v_cvt_pk_bf16_f32 v241, v133, -v137
    v_cvt_pk_bf16_f32 v242, v134, -v138
    v_cvt_pk_bf16_f32 v243, v135, -v139
    buffer_store_dwordx4 v[240:243], v7, s[12:15], s53 offen offset:256 sc1
    s_setprio 0
    v_mov_b32 v10, 152600
L_lw_22:
    ds_read_b32 v11, v10
    s_waitcnt lgkmcnt(0)
    v_cmp_ne_u32 vcc, 4, v11
    s_nop 0
    s_cmp_eq_u64 vcc, 0
    s_cbranch_scc1 L_lwd_23
    s_sleep 1
    s_branch L_lw_22
L_lwd_23:
    s_cmp_eq_u32 s47, 7
    s_cbranch_scc0 L_own_24
    buffer_load_dwordx4 v[28:31], v248, s[12:15], s36 offen offset:0 sc1
    buffer_load_dwordx4 v[32:35], v248, s[12:15], s36 offen offset:1024 sc1
    buffer_load_dwordx4 v[36:39], v248, s[12:15], s36 offen offset:2048 sc1
    buffer_load_dwordx4 v[40:43], v248, s[12:15], s36 offen offset:3072 sc1
L_own_24:
    buffer_load_dwordx4 v[60:63], v248, s[12:15], s37 offen offset:0 sc1
    buffer_load_dwordx4 v[64:67], v248, s[12:15], s37 offen offset:1024 sc1
    buffer_load_dwordx4 v[68:71], v248, s[12:15], s37 offen offset:2048 sc1
    buffer_load_dwordx4 v[72:75], v248, s[12:15], s37 offen offset:3072 sc1
    buffer_load_dwordx4 v[76:79], v248, s[12:15], s38 offen offset:0 sc1
    buffer_load_dwordx4 v[80:83], v248, s[12:15], s38 offen offset:1024 sc1
    buffer_load_dwordx4 v[84:87], v248, s[12:15], s38 offen offset:2048 sc1
    buffer_load_dwordx4 v[88:91], v248, s[12:15], s38 offen offset:3072 sc1
    v_lshl_add_u32 v7, s49, 3, v2
    v_mul_u32_u24 v7, 33792, v7
    v_lshl_add_u32 v7, v1, 4, v7
    v_lshl_add_u32 v7, s62, 8, v7
    v_mov_b32 v10, 152584
L_lw_25:
    ds_read_b32 v11, v10
    s_waitcnt lgkmcnt(0)
    v_cmp_ne_u32 vcc, 4, v11
    s_nop 0
    s_cmp_eq_u64 vcc, 0
    s_cbranch_scc1 L_lwd_26
    s_sleep 1
    s_branch L_lw_25
L_lwd_26:
    v_xor_b32 v244, 16384, v244
    v_xor_b32 v245, 16384, v245
    v_xor_b32 v246, 16384, v246
    v_xor_b32 v247, 16384, v247
    ds_read_b64_tr_b16 v[188:189], v244 offset:0
    ds_read_b64_tr_b16 v[190:191], v244 offset:2048
    ds_read_b64_tr_b16 v[192:193], v245 offset:0
    ds_read_b64_tr_b16 v[194:195], v245 offset:2048
    ds_read_b64_tr_b16 v[196:197], v246 offset:0
    ds_read_b64_tr_b16 v[198:199], v246 offset:2048
    ds_read_b64_tr_b16 v[200:201], v247 offset:0
    ds_read_b64_tr_b16 v[202:203], v247 offset:2048
    ds_read_b64_tr_b16 v[204:205], v244 offset:32768
    ds_read_b64_tr_b16 v[206:207], v244 offset:34816
    ds_read_b64_tr_b16 v[208:209], v245 offset:32768
    ds_read_b64_tr_b16 v[210:211], v245 offset:34816
    ds_read_b64_tr_b16 v[212:213], v246 offset:32768
    ds_read_b64_tr_b16 v[214:215], v246 offset:34816
    ds_read_b64_tr_b16 v[216:217], v247 offset:32768
    ds_read_b64_tr_b16 v[218:219], v247 offset:34816
    v_xor_b32 v244, 65536, v244
    v_xor_b32 v245, 65536, v245
    v_xor_b32 v246, 65536, v246
    v_xor_b32 v247, 65536, v247
    ds_read_b64_tr_b16 v[220:221], v244 offset:0
    ds_read_b64_tr_b16 v[222:223], v244 offset:2048
    ds_read_b64_tr_b16 v[224:225], v245 offset:0
    ds_read_b64_tr_b16 v[226:227], v245 offset:2048
    ds_read_b64_tr_b16 v[228:229], v246 offset:0
    ds_read_b64_tr_b16 v[230:231], v246 offset:2048
    ds_read_b64_tr_b16 v[232:233], v247 offset:0
    ds_read_b64_tr_b16 v[234:235], v247 offset:2048
    s_waitcnt lgkmcnt(0)
    v_mov_b32 v10, 152588
    v_mov_b32 v11, 1
    s_mov_b64 exec, 1
    ds_add_u32 v10, v11
    s_mov_b64 exec, -1
    s_cmp_eq_u32 s47, 7
    s_cbranch_scc0 L_own_27
    s_waitcnt vmcnt(8)
L_own_27:
    v_mfma_f32_16x16x32_bf16 v[92:95], v[188:191], v[28:31], 0
    v_and_b32 v4, 1, v1
    v_bfe_u32 v5, v1, 1, 1
    v_xor_b32 v6, v4, v5
    v_mfma_f32_16x16x32_bf16 v[96:99], v[192:195], v[28:31], 0
    v_lshlrev_b32 v6, 31, v6
    v_lshl_or_b32 v5, v5, 15, v6
    v_lshlrev_b32 v4, 4, v4
    v_mfma_f32_16x16x32_bf16 v[100:103], v[196:199], v[28:31], 0
    v_alignbit_b32 v156, v12, v12, v4
    v_xor_b32 v156, v5, v156
    v_alignbit_b32 v157, v13, v13, v4
    v_mfma_f32_16x16x32_bf16 v[104:107], v[200:203], v[28:31], 0
    v_xor_b32 v157, v5, v157
    v_alignbit_b32 v158, v14, v14, v4
    v_xor_b32 v158, v5, v158
    v_mfma_f32_16x16x32_bf16 v[108:111], v[188:191], v[32:35], 0
    v_alignbit_b32 v159, v15, v15, v4
    v_xor_b32 v159, v5, v159
    v_alignbit_b32 v160, v16, v16, v4
    v_mfma_f32_16x16x32_bf16 v[112:115], v[192:195], v[32:35], 0
    v_xor_b32 v160, v5, v160
    v_alignbit_b32 v161, v17, v17, v4
    v_xor_b32 v161, v5, v161
    v_mfma_f32_16x16x32_bf16 v[116:119], v[196:199], v[32:35], 0
    v_alignbit_b32 v162, v18, v18, v4
    v_xor_b32 v162, v5, v162
    v_alignbit_b32 v163, v19, v19, v4
    v_mfma_f32_16x16x32_bf16 v[120:123], v[200:203], v[32:35], 0
    v_xor_b32 v163, v5, v163
    v_alignbit_b32 v164, v20, v20, v4
    v_xor_b32 v164, v5, v164
    v_mfma_f32_16x16x32_bf16 v[124:127], v[188:191], v[36:39], 0
    v_alignbit_b32 v165, v21, v21, v4
    v_xor_b32 v165, v5, v165
    v_alignbit_b32 v166, v22, v22, v4
    v_mfma_f32_16x16x32_bf16 v[128:131], v[192:195], v[36:39], 0
    v_xor_b32 v166, v5, v166
    v_alignbit_b32 v167, v23, v23, v4
    v_xor_b32 v167, v5, v167
    v_mfma_f32_16x16x32_bf16 v[132:135], v[196:199], v[36:39], 0
    v_alignbit_b32 v168, v24, v24, v4
    v_xor_b32 v168, v5, v168
    v_alignbit_b32 v169, v25, v25, v4
    v_mfma_f32_16x16x32_bf16 v[136:139], v[200:203], v[36:39], 0
    v_xor_b32 v169, v5, v169
    v_alignbit_b32 v170, v26, v26, v4
    v_mfma_f32_16x16x32_bf16 v[140:143], v[188:191], v[40:43], 0
    v_mfma_f32_16x16x32_bf16 v[144:147], v[192:195], v[40:43], 0
    v_mfma_f32_16x16x32_bf16 v[148:151], v[196:199], v[40:43], 0
    v_mfma_f32_16x16x32_bf16 v[152:155], v[200:203], v[40:43], 0
    s_waitcnt vmcnt(4)
    v_mfma_f32_16x16x32_bf16 v[92:95], v[204:207], v[60:63], v[92:95]
    v_xor_b32 v244, 81920, v244
    v_xor_b32 v170, v5, v170
    v_alignbit_b32 v171, v27, v27, v4
    v_xor_b32 v171, v5, v171
    v_mfma_f32_16x16x32_bf16 v[96:99], v[208:211], v[60:63], v[96:99]
    v_xor_b32 v245, 81920, v245
    v_alignbit_b32 v172, v44, v44, v4
    v_xor_b32 v172, v5, v172
    v_alignbit_b32 v173, v45, v45, v4
    v_mfma_f32_16x16x32_bf16 v[100:103], v[212:215], v[60:63], v[100:103]
    v_xor_b32 v246, 81920, v246
    buffer_load_dwordx4 v[28:31], v248, s[12:15], s39 offen offset:0 sc1
    v_xor_b32 v173, v5, v173
    v_alignbit_b32 v174, v46, v46, v4
    v_xor_b32 v174, v5, v174
    v_mfma_f32_16x16x32_bf16 v[104:107], v[216:219], v[60:63], v[104:107]
    v_xor_b32 v247, 81920, v247
    v_alignbit_b32 v175, v47, v47, v4
    v_xor_b32 v175, v5, v175
    v_alignbit_b32 v176, v48, v48, v4
    v_mfma_f32_16x16x32_bf16 v[108:111], v[204:207], v[64:67], v[108:111]
    ds_read_b64_tr_b16 v[188:189], v244 offset:0
    v_xor_b32 v176, v5, v176
    v_alignbit_b32 v177, v49, v49, v4
    v_xor_b32 v177, v5, v177
    v_mfma_f32_16x16x32_bf16 v[112:115], v[208:211], v[64:67], v[112:115]
    ds_read_b64_tr_b16 v[190:191], v244 offset:2048
    v_alignbit_b32 v178, v50, v50, v4
    v_xor_b32 v178, v5, v178
    v_alignbit_b32 v179, v51, v51, v4
    v_mfma_f32_16x16x32_bf16 v[116:119], v[212:215], v[64:67], v[116:119]
    ds_read_b64_tr_b16 v[192:193], v245 offset:0
    buffer_load_dwordx4 v[32:35], v248, s[12:15], s39 offen offset:1024 sc1
    v_xor_b32 v179, v5, v179
    v_alignbit_b32 v180, v52, v52, v4
    v_xor_b32 v180, v5, v180
    v_mfma_f32_16x16x32_bf16 v[120:123], v[216:219], v[64:67], v[120:123]
    ds_read_b64_tr_b16 v[194:195], v245 offset:2048
    v_alignbit_b32 v181, v53, v53, v4
    v_xor_b32 v181, v5, v181
    v_alignbit_b32 v182, v54, v54, v4
    v_mfma_f32_16x16x32_bf16 v[124:127], v[204:207], v[68:71], v[124:127]
    ds_read_b64_tr_b16 v[196:197], v246 offset:0
    v_xor_b32 v182, v5, v182
    v_alignbit_b32 v183, v55, v55, v4
    v_xor_b32 v183, v5, v183
    v_mfma_f32_16x16x32_bf16 v[128:131], v[208:211], v[68:71], v[128:131]
    ds_read_b64_tr_b16 v[198:199], v246 offset:2048
    v_alignbit_b32 v184, v56, v56, v4
    v_xor_b32 v184, v5, v184
    v_alignbit_b32 v185, v57, v57, v4
    v_mfma_f32_16x16x32_bf16 v[132:135], v[212:215], v[68:71], v[132:135]
    ds_read_b64_tr_b16 v[200:201], v247 offset:0
    buffer_load_dwordx4 v[36:39], v248, s[12:15], s39 offen offset:2048 sc1
    v_xor_b32 v185, v5, v185
    v_alignbit_b32 v186, v58, v58, v4
    v_xor_b32 v186, v5, v186
    v_mfma_f32_16x16x32_bf16 v[136:139], v[216:219], v[68:71], v[136:139]
    ds_read_b64_tr_b16 v[202:203], v247 offset:2048
    v_alignbit_b32 v187, v59, v59, v4
    v_xor_b32 v187, v5, v187
    v_mfma_f32_16x16x32_bf16 v[140:143], v[204:207], v[72:75], v[140:143]
    v_mfma_f32_16x16x32_bf16 v[144:147], v[208:211], v[72:75], v[144:147]
    v_mfma_f32_16x16x32_bf16 v[148:151], v[212:215], v[72:75], v[148:151]
    buffer_load_dwordx4 v[40:43], v248, s[12:15], s39 offen offset:3072 sc1
    v_mfma_f32_16x16x32_bf16 v[152:155], v[216:219], v[72:75], v[152:155]
    s_waitcnt vmcnt(4)
    v_mfma_f32_16x16x32_bf16 v[92:95], v[220:223], v[76:79], v[92:95]
    ds_read_b64_tr_b16 v[204:205], v244 offset:32768
    v_mfma_f32_16x16x32_bf16 v[96:99], v[224:227], v[76:79], v[96:99]
    ds_read_b64_tr_b16 v[206:207], v244 offset:34816
    v_mfma_f32_16x16x32_bf16 v[100:103], v[228:231], v[76:79], v[100:103]
    ds_read_b64_tr_b16 v[208:209], v245 offset:32768
    buffer_load_dwordx4 v[60:63], v248, s[12:15], s60 offen offset:0 sc1
    v_mfma_f32_16x16x32_bf16 v[104:107], v[232:235], v[76:79], v[104:107]
    ds_read_b64_tr_b16 v[210:211], v245 offset:34816
    v_mfma_f32_16x16x32_bf16 v[108:111], v[220:223], v[80:83], v[108:111]
    ds_read_b64_tr_b16 v[212:213], v246 offset:32768
    v_mfma_f32_16x16x32_bf16 v[112:115], v[224:227], v[80:83], v[112:115]
    ds_read_b64_tr_b16 v[214:215], v246 offset:34816
    v_mfma_f32_16x16x32_bf16 v[116:119], v[228:231], v[80:83], v[116:119]
    ds_read_b64_tr_b16 v[216:217], v247 offset:32768
    buffer_load_dwordx4 v[64:67], v248, s[12:15], s60 offen offset:1024 sc1
    v_mfma_f32_16x16x32_bf16 v[120:123], v[232:235], v[80:83], v[120:123]
    ds_read_b64_tr_b16 v[218:219], v247 offset:34816
    v_mfma_f32_16x16x32_bf16 v[124:127], v[220:223], v[84:87], v[124:127]
    v_mfma_f32_16x16x32_bf16 v[128:131], v[224:227], v[84:87], v[128:131]
    v_mfma_f32_16x16x32_bf16 v[132:135], v[228:231], v[84:87], v[132:135]
    buffer_load_dwordx4 v[68:71], v248, s[12:15], s60 offen offset:2048 sc1
    v_mfma_f32_16x16x32_bf16 v[136:139], v[232:235], v[84:87], v[136:139]
    v_mfma_f32_16x16x32_bf16 v[140:143], v[220:223], v[88:91], v[140:143]
    v_mfma_f32_16x16x32_bf16 v[144:147], v[224:227], v[88:91], v[144:147]
    v_mfma_f32_16x16x32_bf16 v[148:151], v[228:231], v[88:91], v[148:151]
    buffer_load_dwordx4 v[72:75], v248, s[12:15], s60 offen offset:3072 sc1
    v_mfma_f32_16x16x32_bf16 v[152:155], v[232:235], v[88:91], v[152:155]
    s_waitcnt vmcnt(4)
    s_waitcnt lgkmcnt(8)
    v_mfma_f32_16x16x32_bf16 v[92:95], v[188:191], v[28:31], v[92:95]
    v_xor_b32 v244, 65536, v244
    v_mfma_f32_16x16x32_bf16 v[96:99], v[192:195], v[28:31], v[96:99]
    v_xor_b32 v245, 65536, v245
    v_mfma_f32_16x16x32_bf16 v[100:103], v[196:199], v[28:31], v[100:103]
    v_xor_b32 v246, 65536, v246
    buffer_load_dwordx4 v[76:79], v248, s[12:15], s67 offen offset:0 sc1
    v_mfma_f32_16x16x32_bf16 v[104:107], v[200:203], v[28:31], v[104:107]
    v_xor_b32 v247, 65536, v247
    v_mfma_f32_16x16x32_bf16 v[108:111], v[188:191], v[32:35], v[108:111]
    ds_read_b64_tr_b16 v[220:221], v244 offset:0
    v_mfma_f32_16x16x32_bf16 v[112:115], v[192:195], v[32:35], v[112:115]
    ds_read_b64_tr_b16 v[222:223], v244 offset:2048
    v_mfma_f32_16x16x32_bf16 v[116:119], v[196:199], v[32:35], v[116:119]
    ds_read_b64_tr_b16 v[224:225], v245 offset:0
    buffer_load_dwordx4 v[80:83], v248, s[12:15], s67 offen offset:1024 sc1
    v_mfma_f32_16x16x32_bf16 v[120:123], v[200:203], v[32:35], v[120:123]
    ds_read_b64_tr_b16 v[226:227], v245 offset:2048
    v_mfma_f32_16x16x32_bf16 v[124:127], v[188:191], v[36:39], v[124:127]
    ds_read_b64_tr_b16 v[228:229], v246 offset:0
    v_mfma_f32_16x16x32_bf16 v[128:131], v[192:195], v[36:39], v[128:131]
    ds_read_b64_tr_b16 v[230:231], v246 offset:2048
    v_mfma_f32_16x16x32_bf16 v[132:135], v[196:199], v[36:39], v[132:135]
    ds_read_b64_tr_b16 v[232:233], v247 offset:0
    buffer_load_dwordx4 v[84:87], v248, s[12:15], s67 offen offset:2048 sc1
    v_mfma_f32_16x16x32_bf16 v[136:139], v[200:203], v[36:39], v[136:139]
    ds_read_b64_tr_b16 v[234:235], v247 offset:2048
    v_mfma_f32_16x16x32_bf16 v[140:143], v[188:191], v[40:43], v[140:143]
    v_mfma_f32_16x16x32_bf16 v[144:147], v[192:195], v[40:43], v[144:147]
    v_mfma_f32_16x16x32_bf16 v[148:151], v[196:199], v[40:43], v[148:151]
    buffer_load_dwordx4 v[88:91], v248, s[12:15], s67 offen offset:3072 sc1
    v_mfma_f32_16x16x32_bf16 v[152:155], v[200:203], v[40:43], v[152:155]
    s_waitcnt vmcnt(4)
    s_waitcnt lgkmcnt(8)
    v_mfma_f32_16x16x32_bf16 v[92:95], v[204:207], v[60:63], v[92:95]
    ds_read_b64_tr_b16 v[188:189], v244 offset:32768
    v_mfma_f32_16x16x32_bf16 v[96:99], v[208:211], v[60:63], v[96:99]
    ds_read_b64_tr_b16 v[190:191], v244 offset:34816
    v_mfma_f32_16x16x32_bf16 v[100:103], v[212:215], v[60:63], v[100:103]
    ds_read_b64_tr_b16 v[192:193], v245 offset:32768
    buffer_load_dwordx4 v[28:31], v248, s[12:15], s70 offen offset:0 sc1
    v_mfma_f32_16x16x32_bf16 v[104:107], v[216:219], v[60:63], v[104:107]
    ds_read_b64_tr_b16 v[194:195], v245 offset:34816
    v_mfma_f32_16x16x32_bf16 v[108:111], v[204:207], v[64:67], v[108:111]
    ds_read_b64_tr_b16 v[196:197], v246 offset:32768
    v_mfma_f32_16x16x32_bf16 v[112:115], v[208:211], v[64:67], v[112:115]
    ds_read_b64_tr_b16 v[198:199], v246 offset:34816
    v_mfma_f32_16x16x32_bf16 v[116:119], v[212:215], v[64:67], v[116:119]
    ds_read_b64_tr_b16 v[200:201], v247 offset:32768
    buffer_load_dwordx4 v[32:35], v248, s[12:15], s70 offen offset:1024 sc1
    v_mfma_f32_16x16x32_bf16 v[120:123], v[216:219], v[64:67], v[120:123]
    ds_read_b64_tr_b16 v[202:203], v247 offset:34816
    v_mfma_f32_16x16x32_bf16 v[124:127], v[204:207], v[68:71], v[124:127]
    v_mfma_f32_16x16x32_bf16 v[128:131], v[208:211], v[68:71], v[128:131]
    v_mfma_f32_16x16x32_bf16 v[132:135], v[212:215], v[68:71], v[132:135]
    buffer_load_dwordx4 v[36:39], v248, s[12:15], s70 offen offset:2048 sc1
    v_mfma_f32_16x16x32_bf16 v[136:139], v[216:219], v[68:71], v[136:139]
    v_mfma_f32_16x16x32_bf16 v[140:143], v[204:207], v[72:75], v[140:143]
    v_mfma_f32_16x16x32_bf16 v[144:147], v[208:211], v[72:75], v[144:147]
    v_mfma_f32_16x16x32_bf16 v[148:151], v[212:215], v[72:75], v[148:151]
    buffer_load_dwordx4 v[40:43], v248, s[12:15], s70 offen offset:3072 sc1
    v_mfma_f32_16x16x32_bf16 v[152:155], v[216:219], v[72:75], v[152:155]
    v_mov_b32 v10, 152608
L_lw_28:
    ds_read_b32 v11, v10
    s_waitcnt lgkmcnt(0)
    v_cmp_ne_u32 vcc, 4, v11
    s_nop 0
    s_cmp_eq_u64 vcc, 0
    s_cbranch_scc1 L_lwd_29
    s_sleep 1
    s_branch L_lw_28
L_lwd_29:
    s_waitcnt vmcnt(4)
    s_waitcnt lgkmcnt(8)
    v_mfma_f32_16x16x32_bf16 v[92:95], v[220:223], v[76:79], v[92:95]
    v_mfma_f32_16x16x32_bf16 v[96:99], v[224:227], v[76:79], v[96:99]
    s_mov_b32 s53, 2359296
    buffer_load_dwordx4 v[60:63], v7, s[12:15], s53 offen sc1
    v_mfma_f32_16x16x32_bf16 v[100:103], v[228:231], v[76:79], v[100:103]
    v_mfma_f32_16x16x32_bf16 v[104:107], v[232:235], v[76:79], v[104:107]
    s_mov_b32 s53, 2367744
    buffer_load_dwordx4 v[64:67], v7, s[12:15], s53 offen sc1
    v_mfma_f32_16x16x32_bf16 v[108:111], v[220:223], v[80:83], v[108:111]
    v_mfma_f32_16x16x32_bf16 v[112:115], v[224:227], v[80:83], v[112:115]
    s_mov_b32 s53, 2376192
    buffer_load_dwordx4 v[68:71], v7, s[12:15], s53 offen sc1
    v_mfma_f32_16x16x32_bf16 v[116:119], v[228:231], v[80:83], v[116:119]
    v_mfma_f32_16x16x32_bf16 v[120:123], v[232:235], v[80:83], v[120:123]
    s_mov_b32 s53, 2384640
    buffer_load_dwordx4 v[72:75], v7, s[12:15], s53 offen sc1
    v_mfma_f32_16x16x32_bf16 v[124:127], v[220:223], v[84:87], v[124:127]
    v_mfma_f32_16x16x32_bf16 v[128:131], v[224:227], v[84:87], v[128:131]
    s_mov_b32 s53, 2494464
    buffer_load_dwordx4 v[204:207], v7, s[12:15], s53 offen sc1
    v_mfma_f32_16x16x32_bf16 v[132:135], v[228:231], v[84:87], v[132:135]
    v_mfma_f32_16x16x32_bf16 v[136:139], v[232:235], v[84:87], v[136:139]
    s_mov_b32 s53, 2502912
    buffer_load_dwordx4 v[208:211], v7, s[12:15], s53 offen sc1
    v_mfma_f32_16x16x32_bf16 v[140:143], v[220:223], v[88:91], v[140:143]
    v_mfma_f32_16x16x32_bf16 v[144:147], v[224:227], v[88:91], v[144:147]
    s_mov_b32 s53, 2511360
    buffer_load_dwordx4 v[212:215], v7, s[12:15], s53 offen sc1
    v_mfma_f32_16x16x32_bf16 v[148:151], v[228:231], v[88:91], v[148:151]
    v_mfma_f32_16x16x32_bf16 v[152:155], v[232:235], v[88:91], v[152:155]
    s_mov_b32 s53, 2519808
    buffer_load_dwordx4 v[216:219], v7, s[12:15], s53 offen sc1
    s_waitcnt vmcnt(8)
    s_waitcnt lgkmcnt(0)
    v_mfma_f32_16x16x32_bf16 v[92:95], v[188:191], v[28:31], v[92:95]
    v_mfma_f32_16x16x32_bf16 v[96:99], v[192:195], v[28:31], v[96:99]
    s_mov_b32 s53, 3440640
    buffer_load_dwordx4 v[76:79], v7, s[12:15], s53 offen sc1
    v_mfma_f32_16x16x32_bf16 v[100:103], v[196:199], v[28:31], v[100:103]
    v_mfma_f32_16x16x32_bf16 v[104:107], v[200:203], v[28:31], v[104:107]
    s_mov_b32 s53, 3449088
    buffer_load_dwordx4 v[80:83], v7, s[12:15], s53 offen sc1
    v_mfma_f32_16x16x32_bf16 v[108:111], v[188:191], v[32:35], v[108:111]
    v_mfma_f32_16x16x32_bf16 v[112:115], v[192:195], v[32:35], v[112:115]
    s_mov_b32 s53, 3457536
    buffer_load_dwordx4 v[84:87], v7, s[12:15], s53 offen sc1
    v_mfma_f32_16x16x32_bf16 v[116:119], v[196:199], v[32:35], v[116:119]
    v_mfma_f32_16x16x32_bf16 v[120:123], v[200:203], v[32:35], v[120:123]
    s_mov_b32 s53, 3465984
    buffer_load_dwordx4 v[88:91], v7, s[12:15], s53 offen sc1
    v_mfma_f32_16x16x32_bf16 v[124:127], v[188:191], v[36:39], v[124:127]
    v_mfma_f32_16x16x32_bf16 v[128:131], v[192:195], v[36:39], v[128:131]
    s_mov_b32 s53, 3575808
    buffer_load_dwordx4 v[220:223], v7, s[12:15], s53 offen sc1
    v_mfma_f32_16x16x32_bf16 v[132:135], v[196:199], v[36:39], v[132:135]
    v_mfma_f32_16x16x32_bf16 v[136:139], v[200:203], v[36:39], v[136:139]
    s_mov_b32 s53, 3584256
    buffer_load_dwordx4 v[224:227], v7, s[12:15], s53 offen sc1
    v_mfma_f32_16x16x32_bf16 v[140:143], v[188:191], v[40:43], v[140:143]
    v_mfma_f32_16x16x32_bf16 v[144:147], v[192:195], v[40:43], v[144:147]
    s_mov_b32 s53, 3592704
    buffer_load_dwordx4 v[228:231], v7, s[12:15], s53 offen sc1
    v_mfma_f32_16x16x32_bf16 v[148:151], v[196:199], v[40:43], v[148:151]
    v_mfma_f32_16x16x32_bf16 v[152:155], v[200:203], v[40:43], v[152:155]
    s_mov_b32 s53, 3601152
    buffer_load_dwordx4 v[232:235], v7, s[12:15], s53 offen sc1
    s_waitcnt vmcnt(12)
    s_mov_b32 s61, 0x40000
L_sp_30:
    v_max3_u32 v10, v60, v61, v62
    v_max3_u32 v10, v10, v63, v64
    v_max3_u32 v10, v10, v65, v66
    v_max3_u32 v10, v10, v67, v68
    v_max3_u32 v10, v10, v69, v70
    v_max3_u32 v10, v10, v71, v72
    v_max3_u32 v10, v10, v73, v74
    v_max_u32 v10, v10, v75
    v_cmp_eq_u32 vcc, -1, v10
    s_nop 0
    s_cmp_eq_u64 vcc, 0
    s_cbranch_scc1 L_sd_31
    s_sleep 12
    s_mov_b32 s53, 2359296
    buffer_load_dwordx4 v[60:63], v7, s[12:15], s53 offen sc1
    s_mov_b32 s53, 2367744
    buffer_load_dwordx4 v[64:67], v7, s[12:15], s53 offen sc1
    s_mov_b32 s53, 2376192
    buffer_load_dwordx4 v[68:71], v7, s[12:15], s53 offen sc1
    s_mov_b32 s53, 2384640
    buffer_load_dwordx4 v[72:75], v7, s[12:15], s53 offen sc1
    s_waitcnt vmcnt(0)
    s_sub_u32 s61, s61, 1
    s_cbranch_scc0 L_sp_30
L_sd_31:
    v_swap_b32 v61, v64
    v_swap_b32 v62, v68
    v_swap_b32 v63, v72
    v_swap_b32 v66, v69
    v_swap_b32 v67, v73
    v_swap_b32 v71, v74
    v_mfma_f32_16x16x32_bf16 v[92:95], v[12:15], v[60:63], v[92:95]
    v_mfma_f32_16x16x32_bf16 v[96:99], v[16:19], v[60:63], v[96:99]
    v_mfma_f32_16x16x32_bf16 v[100:103], v[20:23], v[60:63], v[100:103]
    v_mfma_f32_16x16x32_bf16 v[104:107], v[24:27], v[60:63], v[104:107]
    v_mfma_f32_16x16x32_bf16 v[108:111], v[12:15], v[64:67], v[108:111]
    v_mfma_f32_16x16x32_bf16 v[112:115], v[16:19], v[64:67], v[112:115]
    v_mfma_f32_16x16x32_bf16 v[116:119], v[20:23], v[64:67], v[116:119]
    v_mfma_f32_16x16x32_bf16 v[120:123], v[24:27], v[64:67], v[120:123]
    v_mfma_f32_16x16x32_bf16 v[124:127], v[12:15], v[68:71], v[124:127]
    v_mfma_f32_16x16x32_bf16 v[128:131], v[16:19], v[68:71], v[128:131]
    v_mfma_f32_16x16x32_bf16 v[132:135], v[20:23], v[68:71], v[132:135]
    v_mfma_f32_16x16x32_bf16 v[136:139], v[24:27], v[68:71], v[136:139]
    v_mfma_f32_16x16x32_bf16 v[140:143], v[12:15], v[72:75], v[140:143]
    v_mfma_f32_16x16x32_bf16 v[144:147], v[16:19], v[72:75], v[144:147]
    v_mfma_f32_16x16x32_bf16 v[148:151], v[20:23], v[72:75], v[148:151]
    v_mfma_f32_16x16x32_bf16 v[152:155], v[24:27], v[72:75], v[152:155]
    s_waitcnt vmcnt(8)
    s_mov_b32 s61, 0x40000
L_sp_32:
    v_max3_u32 v10, v204, v205, v206
    v_max3_u32 v10, v10, v207, v208
    v_max3_u32 v10, v10, v209, v210
    v_max3_u32 v10, v10, v211, v212
    v_max3_u32 v10, v10, v213, v214
    v_max3_u32 v10, v10, v215, v216
    v_max3_u32 v10, v10, v217, v218
    v_max_u32 v10, v10, v219
    v_cmp_eq_u32 vcc, -1, v10
    s_nop 0
    s_cmp_eq_u64 vcc, 0
    s_cbranch_scc1 L_sd_33
    s_sleep 12
    s_mov_b32 s53, 2494464
    buffer_load_dwordx4 v[204:207], v7, s[12:15], s53 offen sc1
    s_mov_b32 s53, 2502912
    buffer_load_dwordx4 v[208:211], v7, s[12:15], s53 offen sc1
    s_mov_b32 s53, 2511360
    buffer_load_dwordx4 v[212:215], v7, s[12:15], s53 offen sc1
    s_mov_b32 s53, 2519808
    buffer_load_dwordx4 v[216:219], v7, s[12:15], s53 offen sc1
    s_waitcnt vmcnt(0)
    s_sub_u32 s61, s61, 1
    s_cbranch_scc0 L_sp_32
L_sd_33:
    v_swap_b32 v205, v208
    v_swap_b32 v206, v212
    v_swap_b32 v207, v216
    v_swap_b32 v210, v213
    v_swap_b32 v211, v217
    v_swap_b32 v215, v218
    v_mfma_f32_16x16x32_bf16 v[92:95], v[44:47], v[204:207], v[92:95]
    v_mfma_f32_16x16x32_bf16 v[96:99], v[48:51], v[204:207], v[96:99]
    v_mfma_f32_16x16x32_bf16 v[100:103], v[52:55], v[204:207], v[100:103]
    v_mfma_f32_16x16x32_bf16 v[104:107], v[56:59], v[204:207], v[104:107]
    v_mfma_f32_16x16x32_bf16 v[108:111], v[44:47], v[208:211], v[108:111]
    buffer_load_dwordx4 v[236:239], v250, s[4:7], 0 offen
    v_mfma_f32_16x16x32_bf16 v[112:115], v[48:51], v[208:211], v[112:115]
    v_mfma_f32_16x16x32_bf16 v[116:119], v[52:55], v[208:211], v[116:119]
    v_mfma_f32_16x16x32_bf16 v[120:123], v[56:59], v[208:211], v[120:123]
    v_mfma_f32_16x16x32_bf16 v[124:127], v[44:47], v[212:215], v[124:127]
    v_mfma_f32_16x16x32_bf16 v[128:131], v[48:51], v[212:215], v[128:131]
    v_mfma_f32_16x16x32_bf16 v[132:135], v[52:55], v[212:215], v[132:135]
    v_mfma_f32_16x16x32_bf16 v[136:139], v[56:59], v[212:215], v[136:139]
    v_mfma_f32_16x16x32_bf16 v[140:143], v[44:47], v[216:219], v[140:143]
    buffer_load_dwordx4 v[240:243], v251, s[28:31], 0 offen
    v_mfma_f32_16x16x32_bf16 v[144:147], v[48:51], v[216:219], v[144:147]
    v_mfma_f32_16x16x32_bf16 v[148:151], v[52:55], v[216:219], v[148:151]
    v_mfma_f32_16x16x32_bf16 v[152:155], v[56:59], v[216:219], v[152:155]
    s_waitcnt vmcnt(6)
    s_mov_b32 s61, 0x40000
L_sp_34:
    v_max3_u32 v10, v76, v77, v78
    v_max3_u32 v10, v10, v79, v80
    v_max3_u32 v10, v10, v81, v82
    v_max3_u32 v10, v10, v83, v84
    v_max3_u32 v10, v10, v85, v86
    v_max3_u32 v10, v10, v87, v88
    v_max3_u32 v10, v10, v89, v90
    v_max_u32 v10, v10, v91
    v_cmp_eq_u32 vcc, -1, v10
    s_nop 0
    s_cmp_eq_u64 vcc, 0
    s_cbranch_scc1 L_sd_35
    s_sleep 12
    s_mov_b32 s53, 3440640
    buffer_load_dwordx4 v[76:79], v7, s[12:15], s53 offen sc1
    s_mov_b32 s53, 3449088
    buffer_load_dwordx4 v[80:83], v7, s[12:15], s53 offen sc1
    s_mov_b32 s53, 3457536
    buffer_load_dwordx4 v[84:87], v7, s[12:15], s53 offen sc1
    s_mov_b32 s53, 3465984
    buffer_load_dwordx4 v[88:91], v7, s[12:15], s53 offen sc1
    s_waitcnt vmcnt(0)
    s_sub_u32 s61, s61, 1
    s_cbranch_scc0 L_sp_34
L_sd_35:
    v_swap_b32 v77, v80
    v_swap_b32 v78, v84
    v_swap_b32 v79, v88
    v_swap_b32 v82, v85
    v_swap_b32 v83, v89
    v_swap_b32 v87, v90
    v_mfma_f32_16x16x32_bf16 v[92:95], v[156:159], v[76:79], v[92:95]
    v_xor_b32 v188, v2, v1
    v_mfma_f32_16x16x32_bf16 v[96:99], v[160:163], v[76:79], v[96:99]
    v_lshlrev_b32 v188, 4, v188
    v_mfma_f32_16x16x32_bf16 v[100:103], v[164:167], v[76:79], v[100:103]
    v_lshl_add_u32 v188, v1, 8, v188
    v_mfma_f32_16x16x32_bf16 v[104:107], v[168:171], v[76:79], v[104:107]
    v_add_u32 v188, s58, v188
    v_mfma_f32_16x16x32_bf16 v[108:111], v[156:159], v[80:83], v[108:111]
    v_xor_b32 v189, 64, v188
    v_mfma_f32_16x16x32_bf16 v[112:115], v[160:163], v[80:83], v[112:115]
    v_xor_b32 v190, 128, v188
    v_mfma_f32_16x16x32_bf16 v[116:119], v[164:167], v[80:83], v[116:119]
    v_xor_b32 v191, 192, v188
    v_mfma_f32_16x16x32_bf16 v[120:123], v[168:171], v[80:83], v[120:123]
    v_add_u32 v192, 0x10000, v188
    v_mfma_f32_16x16x32_bf16 v[124:127], v[156:159], v[84:87], v[124:127]
    v_add_u32 v193, 0x10000, v189
    v_mfma_f32_16x16x32_bf16 v[128:131], v[160:163], v[84:87], v[128:131]
    v_add_u32 v194, 0x10000, v190
    v_mfma_f32_16x16x32_bf16 v[132:135], v[164:167], v[84:87], v[132:135]
    v_add_u32 v195, 0x10000, v191
    v_mfma_f32_16x16x32_bf16 v[136:139], v[168:171], v[84:87], v[136:139]
    v_mfma_f32_16x16x32_bf16 v[140:143], v[156:159], v[88:91], v[140:143]
    v_mfma_f32_16x16x32_bf16 v[144:147], v[160:163], v[88:91], v[144:147]
    v_mfma_f32_16x16x32_bf16 v[148:151], v[164:167], v[88:91], v[148:151]
    v_mfma_f32_16x16x32_bf16 v[152:155], v[168:171], v[88:91], v[152:155]
    v_mov_b32 v10, 152592
L_lw_36:
    ds_read_b32 v11, v10
    s_waitcnt lgkmcnt(0)
    v_cmp_ne_u32 vcc, 4, v11
    s_nop 0
    s_cmp_eq_u64 vcc, 0
    s_cbranch_scc1 L_lwd_37
    s_sleep 1
    s_branch L_lw_36
L_lwd_37:
    s_waitcnt vmcnt(2)
    s_mov_b32 s61, 0x40000
L_sp_38:
    v_max3_u32 v10, v220, v221, v222
    v_max3_u32 v10, v10, v223, v224
    v_max3_u32 v10, v10, v225, v226
    v_max3_u32 v10, v10, v227, v228
    v_max3_u32 v10, v10, v229, v230
    v_max3_u32 v10, v10, v231, v232
    v_max3_u32 v10, v10, v233, v234
    v_max_u32 v10, v10, v235
    v_cmp_eq_u32 vcc, -1, v10
    s_nop 0
    s_cmp_eq_u64 vcc, 0
    s_cbranch_scc1 L_sd_39
    s_sleep 12
    s_mov_b32 s53, 3575808
    buffer_load_dwordx4 v[220:223], v7, s[12:15], s53 offen sc1
    s_mov_b32 s53, 3584256
    buffer_load_dwordx4 v[224:227], v7, s[12:15], s53 offen sc1
    s_mov_b32 s53, 3592704
    buffer_load_dwordx4 v[228:231], v7, s[12:15], s53 offen sc1
    s_mov_b32 s53, 3601152
    buffer_load_dwordx4 v[232:235], v7, s[12:15], s53 offen sc1
    s_waitcnt vmcnt(0)
    s_sub_u32 s61, s61, 1
    s_cbranch_scc0 L_sp_38
L_sd_39:
    v_swap_b32 v221, v224
    v_swap_b32 v222, v228
    v_swap_b32 v223, v232
    v_swap_b32 v226, v229
    v_swap_b32 v227, v233
    v_swap_b32 v231, v234
    v_mfma_f32_16x16x32_bf16 v[92:95], v[172:175], v[220:223], v[92:95]
    v_mfma_f32_16x16x32_bf16 v[96:99], v[176:179], v[220:223], v[96:99]
    v_mfma_f32_16x16x32_bf16 v[100:103], v[180:183], v[220:223], v[100:103]
    v_mfma_f32_16x16x32_bf16 v[104:107], v[184:187], v[220:223], v[104:107]
    v_mfma_f32_16x16x32_bf16 v[108:111], v[172:175], v[224:227], v[108:111]
    s_nop 3
    ds_write_b128 v188, v[92:95] offset:0
    v_mfma_f32_16x16x32_bf16 v[112:115], v[176:179], v[224:227], v[112:115]
    ds_write_b128 v189, v[96:99] offset:0
    v_mfma_f32_16x16x32_bf16 v[116:119], v[180:183], v[224:227], v[116:119]
    ds_write_b128 v190, v[100:103] offset:0
    v_mfma_f32_16x16x32_bf16 v[120:123], v[184:187], v[224:227], v[120:123]
    ds_write_b128 v191, v[104:107] offset:0
    v_mfma_f32_16x16x32_bf16 v[124:127], v[172:175], v[228:231], v[124:127]
    ds_write_b128 v188, v[108:111] offset:32768
    v_mfma_f32_16x16x32_bf16 v[128:131], v[176:179], v[228:231], v[128:131]
    ds_write_b128 v189, v[112:115] offset:32768
    v_mfma_f32_16x16x32_bf16 v[132:135], v[180:183], v[228:231], v[132:135]
    ds_write_b128 v190, v[116:119] offset:32768
    v_mfma_f32_16x16x32_bf16 v[136:139], v[184:187], v[228:231], v[136:139]
    ds_write_b128 v191, v[120:123] offset:32768
    v_mfma_f32_16x16x32_bf16 v[140:143], v[172:175], v[232:235], v[140:143]
    ds_write_b128 v192, v[124:127] offset:0
    v_mfma_f32_16x16x32_bf16 v[144:147], v[176:179], v[232:235], v[144:147]
    ds_write_b128 v193, v[128:131] offset:0
    v_mfma_f32_16x16x32_bf16 v[148:151], v[180:183], v[232:235], v[148:151]
    ds_write_b128 v194, v[132:135] offset:0
    v_mfma_f32_16x16x32_bf16 v[152:155], v[184:187], v[232:235], v[152:155]
    ds_write_b128 v195, v[136:139] offset:0
    s_nop 0
    ds_write_b128 v192, v[140:143] offset:32768
    s_nop 0
    ds_write_b128 v193, v[144:147] offset:32768
    s_nop 0
    ds_write_b128 v194, v[148:151] offset:32768
    s_nop 0
    ds_write_b128 v195, v[152:155] offset:32768
    s_branch L_red_13
L_bwave_11:
    v_lshrrev_b32 v68, 2, v1
    v_lshl_add_u32 v68, v2, 2, v68
    v_bfe_u32 v69, v68, 1, 2
    v_lshlrev_b32 v69, 5, v69
    v_lshl_add_u32 v68, v68, 7, v69
    v_and_b32 v69, 3, v1
    v_lshl_add_u32 v68, v69, 3, v68
    v_lshl_add_u32 v244, s49, 12, v68
    v_xor_b32 v245, 32, v244
    v_xor_b32 v246, 64, v244
    v_xor_b32 v247, 96, v244
    s_xor_b32 s52, s62, s48
    s_lshl1_add_u32 s52, s52, s46
    s_mul_i32 s52, s52, 28
    s_add_u32 s52, s52, s49
    s_lshl_b32 s52, s52, 12
    s_add_u32 s52, s52, 7077888
    v_lshl_add_u32 v248, v0, 4, s52
    s_lshr_b32 s52, s62, 1
    s_lshr_b32 s53, s44, 1
    s_lshl2_add_u32 s52, s52, s53
    s_and_b32 s53, s62, 1
    s_lshl1_add_u32 s52, s52, s53
    s_and_b32 s53, s44, 1
    s_lshl1_add_u32 s52, s52, s53
    v_lshrrev_b32 v68, 3, v0
    v_lshl_add_u32 v68, s52, 3, v68
    v_and_b32 v69, 7, v0
    v_lshlrev_b32 v69, 4, v69
    v_lshl_add_u32 v251, s65, 7, v69
    v_lshl_add_u32 v250, v68, 10, v251
    s_mov_b32 s30, 1024
    s_mov_b32 s31, 0x20000
    s_mov_b32 s34, 2097152
    s_mov_b32 s35, 0x20000
    s_lshl3_add_u32 s52, s62, s65
    s_lshl3_add_u32 s52, s52, s49
    s_lshl_b32 s52, s52, 7
    s_add_u32 s52, s52, 15204352
    v_and_b32 v249, 7, v0
    v_min_u32 v249, 6, v249
    v_lshl_add_u32 v249, v249, 4, s52
    v_bfe_u32 v8, v0, 3, 1
    v_lshl_add_u32 v249, v8, 9, v249
    v_and_b32 v253, 31, v0
    v_lshrrev_b32 v8, 5, v0
    v_lshl_add_u32 v253, v8, 7, v253
    s_lshl_b32 s52, s49, 9
    s_add_u32 s52, s52, 14721024
    v_lshl_add_u32 v253, v253, 4, s52
    s_waitcnt vmcnt(0)
    s_mov_b64 exec, 255
    buffer_store_dword v255, v254, s[12:15], 0 offen sc1
    s_mov_b64 exec, -1
    v_mov_b32 v10, 152584
    v_mov_b32 v11, 1
    s_mov_b64 exec, 1
    ds_add_u32 v10, v11
    s_mov_b64 exec, -1
    s_bitcmp1_b32 s49, 0
    s_cbranch_scc0 L_nsw_40
    v_swap_b32 v28, v32
    v_swap_b32 v29, v33
    v_swap_b32 v30, v34
    v_swap_b32 v31, v35
    v_swap_b32 v36, v40
    v_swap_b32 v37, v41
    v_swap_b32 v38, v42
    v_swap_b32 v39, v43
L_nsw_40:
    s_bitcmp1_b32 s49, 1
    s_cbranch_scc0 L_nsw_41
    v_swap_b32 v28, v36
    v_swap_b32 v29, v37
    v_swap_b32 v30, v38
    v_swap_b32 v31, v39
    v_swap_b32 v32, v40
    v_swap_b32 v33, v41
    v_swap_b32 v34, v42
    v_swap_b32 v35, v43
L_nsw_41:
    v_xor_b32 v244, 16384, v244
    v_xor_b32 v245, 16384, v245
    v_xor_b32 v246, 16384, v246
    v_xor_b32 v247, 16384, v247
    ds_read_b64_tr_b16 v[188:189], v244 offset:0
    ds_read_b64_tr_b16 v[190:191], v244 offset:2048
    ds_read_b64_tr_b16 v[192:193], v245 offset:0
    ds_read_b64_tr_b16 v[194:195], v245 offset:2048
    ds_read_b64_tr_b16 v[196:197], v246 offset:0
    ds_read_b64_tr_b16 v[198:199], v246 offset:2048
    ds_read_b64_tr_b16 v[200:201], v247 offset:0
    ds_read_b64_tr_b16 v[202:203], v247 offset:2048
    ds_read_b64_tr_b16 v[204:205], v244 offset:32768
    ds_read_b64_tr_b16 v[206:207], v244 offset:34816
    ds_read_b64_tr_b16 v[208:209], v245 offset:32768
    ds_read_b64_tr_b16 v[210:211], v245 offset:34816
    ds_read_b64_tr_b16 v[212:213], v246 offset:32768
    ds_read_b64_tr_b16 v[214:215], v246 offset:34816
    ds_read_b64_tr_b16 v[216:217], v247 offset:32768
    ds_read_b64_tr_b16 v[218:219], v247 offset:34816
    v_xor_b32 v244, 65536, v244
    v_xor_b32 v245, 65536, v245
    v_xor_b32 v246, 65536, v246
    v_xor_b32 v247, 65536, v247
    ds_read_b64_tr_b16 v[220:221], v244 offset:0
    ds_read_b64_tr_b16 v[222:223], v244 offset:2048
    ds_read_b64_tr_b16 v[224:225], v245 offset:0
    ds_read_b64_tr_b16 v[226:227], v245 offset:2048
    ds_read_b64_tr_b16 v[228:229], v246 offset:0
    ds_read_b64_tr_b16 v[230:231], v246 offset:2048
    ds_read_b64_tr_b16 v[232:233], v247 offset:0
    ds_read_b64_tr_b16 v[234:235], v247 offset:2048
    s_waitcnt lgkmcnt(0)
    v_mov_b32 v10, 152612
    v_mov_b32 v11, 1
    s_mov_b64 exec, 1
    ds_add_u32 v10, v11
    s_mov_b64 exec, -1
    s_cmp_eq_u32 s44, 7
    s_cbranch_scc0 L_noe1_42
    v_mov_b32 v10, 152612
L_lw_43:
    ds_read_b32 v11, v10
    s_waitcnt lgkmcnt(0)
    v_cmp_ne_u32 vcc, 8, v11
    s_nop 0
    s_cmp_eq_u64 vcc, 0
    s_cbranch_scc1 L_lwd_44
    s_sleep 1
    s_branch L_lw_43
L_lwd_44:
    s_lshl4_add_u32 s52, s2, 14721024
    v_mov_b32 v10, s52
    s_mov_b64 exec, 1
    buffer_store_dword v255, v10, s[12:15], 0 offen sc1
    s_mov_b64 exec, -1
L_noe1_42:
    v_mov_b32 v10, 152580
L_lw_45:
    ds_read_b32 v11, v10
    s_waitcnt lgkmcnt(0)
    v_cmp_ne_u32 vcc, 4, v11
    s_nop 0
    s_cmp_eq_u64 vcc, 0
    s_cbranch_scc1 L_lwd_46
    s_sleep 1
    s_branch L_lw_45
L_lwd_46:
    buffer_load_dword v9, v249, s[12:15], 0 offen sc1
    s_waitcnt vmcnt(0)
    s_mov_b32 s61, 0x40000
L_poll_47:
    v_cmp_ne_u32 vcc, v255, v9
    s_nop 0
    s_cmp_eq_u64 vcc, 0
    s_cbranch_scc1 L_polled_48
    s_sleep 10
    buffer_load_dword v9, v249, s[12:15], 0 offen sc1
    s_waitcnt vmcnt(0)
    s_sub_u32 s61, s61, 1
    s_cbranch_scc0 L_poll_47
L_polled_48:
    v_mov_b32 v10, 152600
    v_mov_b32 v11, 1
    s_mov_b64 exec, 1
    ds_add_u32 v10, v11
    s_mov_b64 exec, -1
    s_setprio 0
    s_cmp_eq_u32 s47, 7
    s_cbranch_scc0 L_own_49
    buffer_load_dwordx4 v[28:31], v248, s[12:15], s36 offen offset:0 sc1
    buffer_load_dwordx4 v[32:35], v248, s[12:15], s36 offen offset:1024 sc1
    buffer_load_dwordx4 v[36:39], v248, s[12:15], s36 offen offset:2048 sc1
    buffer_load_dwordx4 v[40:43], v248, s[12:15], s36 offen offset:3072 sc1
L_own_49:
    buffer_load_dwordx4 v[12:15], v248, s[12:15], s37 offen offset:0 sc1
    buffer_load_dwordx4 v[16:19], v248, s[12:15], s37 offen offset:1024 sc1
    buffer_load_dwordx4 v[20:23], v248, s[12:15], s37 offen offset:2048 sc1
    buffer_load_dwordx4 v[24:27], v248, s[12:15], s37 offen offset:3072 sc1
    buffer_load_dwordx4 v[44:47], v248, s[12:15], s38 offen offset:0 sc1
    buffer_load_dwordx4 v[48:51], v248, s[12:15], s38 offen offset:1024 sc1
    buffer_load_dwordx4 v[52:55], v248, s[12:15], s38 offen offset:2048 sc1
    buffer_load_dwordx4 v[56:59], v248, s[12:15], s38 offen offset:3072 sc1
    buffer_load_dwordx4 v[60:63], v248, s[12:15], s39 offen offset:0 sc1
    buffer_load_dwordx4 v[64:67], v248, s[12:15], s39 offen offset:1024 sc1
    buffer_load_dwordx4 v[68:71], v248, s[12:15], s39 offen offset:2048 sc1
    buffer_load_dwordx4 v[72:75], v248, s[12:15], s39 offen offset:3072 sc1
    buffer_load_dwordx4 v[76:79], v248, s[12:15], s60 offen offset:0 sc1
    buffer_load_dwordx4 v[80:83], v248, s[12:15], s60 offen offset:1024 sc1
    buffer_load_dwordx4 v[84:87], v248, s[12:15], s60 offen offset:2048 sc1
    buffer_load_dwordx4 v[88:91], v248, s[12:15], s60 offen offset:3072 sc1
    s_cmp_eq_u32 s47, 7
    s_cbranch_scc0 L_own_50
    s_waitcnt vmcnt(16)
L_own_50:
    v_mfma_f32_16x16x32_bf16 v[92:95], v[188:191], v[28:31], 0
    v_mfma_f32_16x16x32_bf16 v[96:99], v[192:195], v[28:31], 0
    v_mfma_f32_16x16x32_bf16 v[100:103], v[196:199], v[28:31], 0
    v_mfma_f32_16x16x32_bf16 v[104:107], v[200:203], v[28:31], 0
    v_mfma_f32_16x16x32_bf16 v[108:111], v[188:191], v[32:35], 0
    v_mfma_f32_16x16x32_bf16 v[112:115], v[192:195], v[32:35], 0
    v_mfma_f32_16x16x32_bf16 v[116:119], v[196:199], v[32:35], 0
    v_mfma_f32_16x16x32_bf16 v[120:123], v[200:203], v[32:35], 0
    v_mfma_f32_16x16x32_bf16 v[124:127], v[188:191], v[36:39], 0
    v_mfma_f32_16x16x32_bf16 v[128:131], v[192:195], v[36:39], 0
    v_mfma_f32_16x16x32_bf16 v[132:135], v[196:199], v[36:39], 0
    v_mfma_f32_16x16x32_bf16 v[136:139], v[200:203], v[36:39], 0
    v_mfma_f32_16x16x32_bf16 v[140:143], v[188:191], v[40:43], 0
    v_mfma_f32_16x16x32_bf16 v[144:147], v[192:195], v[40:43], 0
    v_mfma_f32_16x16x32_bf16 v[148:151], v[196:199], v[40:43], 0
    v_mfma_f32_16x16x32_bf16 v[152:155], v[200:203], v[40:43], 0
    v_mov_b32 v10, 152604
L_lw_51:
    ds_read_b32 v11, v10
    s_waitcnt lgkmcnt(0)
    v_cmp_ne_u32 vcc, 4, v11
    s_nop 0
    s_cmp_eq_u64 vcc, 0
    s_cbranch_scc1 L_lwd_52
    s_sleep 1
    s_branch L_lw_51
L_lwd_52:
    s_waitcnt vmcnt(12)
    v_mfma_f32_16x16x32_bf16 v[92:95], v[204:207], v[12:15], v[92:95]
    v_xor_b32 v244, 81920, v244
    v_mfma_f32_16x16x32_bf16 v[96:99], v[208:211], v[12:15], v[96:99]
    v_xor_b32 v245, 81920, v245
    v_mfma_f32_16x16x32_bf16 v[100:103], v[212:215], v[12:15], v[100:103]
    v_xor_b32 v246, 81920, v246
    buffer_load_dwordx4 v[156:159], v248, s[12:15], s67 offen offset:0 sc1
    v_mfma_f32_16x16x32_bf16 v[104:107], v[216:219], v[12:15], v[104:107]
    v_xor_b32 v247, 81920, v247
    v_mfma_f32_16x16x32_bf16 v[108:111], v[204:207], v[16:19], v[108:111]
    ds_read_b64_tr_b16 v[188:189], v244 offset:0
    v_mfma_f32_16x16x32_bf16 v[112:115], v[208:211], v[16:19], v[112:115]
    ds_read_b64_tr_b16 v[190:191], v244 offset:2048
    v_mfma_f32_16x16x32_bf16 v[116:119], v[212:215], v[16:19], v[116:119]
    ds_read_b64_tr_b16 v[192:193], v245 offset:0
    buffer_load_dwordx4 v[160:163], v248, s[12:15], s67 offen offset:1024 sc1
    v_mfma_f32_16x16x32_bf16 v[120:123], v[216:219], v[16:19], v[120:123]
    ds_read_b64_tr_b16 v[194:195], v245 offset:2048
    v_mfma_f32_16x16x32_bf16 v[124:127], v[204:207], v[20:23], v[124:127]
    ds_read_b64_tr_b16 v[196:197], v246 offset:0
    v_mfma_f32_16x16x32_bf16 v[128:131], v[208:211], v[20:23], v[128:131]
    ds_read_b64_tr_b16 v[198:199], v246 offset:2048
    v_mfma_f32_16x16x32_bf16 v[132:135], v[212:215], v[20:23], v[132:135]
    ds_read_b64_tr_b16 v[200:201], v247 offset:0
    buffer_load_dwordx4 v[164:167], v248, s[12:15], s67 offen offset:2048 sc1
    v_mfma_f32_16x16x32_bf16 v[136:139], v[216:219], v[20:23], v[136:139]
    ds_read_b64_tr_b16 v[202:203], v247 offset:2048
    v_mfma_f32_16x16x32_bf16 v[140:143], v[204:207], v[24:27], v[140:143]
    v_mfma_f32_16x16x32_bf16 v[144:147], v[208:211], v[24:27], v[144:147]
    v_mfma_f32_16x16x32_bf16 v[148:151], v[212:215], v[24:27], v[148:151]
    buffer_load_dwordx4 v[168:171], v248, s[12:15], s67 offen offset:3072 sc1
    v_mfma_f32_16x16x32_bf16 v[152:155], v[216:219], v[24:27], v[152:155]
    s_waitcnt vmcnt(12)
    v_mfma_f32_16x16x32_bf16 v[92:95], v[220:223], v[44:47], v[92:95]
    ds_read_b64_tr_b16 v[204:205], v244 offset:32768
    v_mfma_f32_16x16x32_bf16 v[96:99], v[224:227], v[44:47], v[96:99]
    ds_read_b64_tr_b16 v[206:207], v244 offset:34816
    v_mfma_f32_16x16x32_bf16 v[100:103], v[228:231], v[44:47], v[100:103]
    ds_read_b64_tr_b16 v[208:209], v245 offset:32768
    buffer_load_dwordx4 v[172:175], v248, s[12:15], s70 offen offset:0 sc1
    v_mfma_f32_16x16x32_bf16 v[104:107], v[232:235], v[44:47], v[104:107]
    ds_read_b64_tr_b16 v[210:211], v245 offset:34816
    v_mfma_f32_16x16x32_bf16 v[108:111], v[220:223], v[48:51], v[108:111]
    ds_read_b64_tr_b16 v[212:213], v246 offset:32768
    v_mfma_f32_16x16x32_bf16 v[112:115], v[224:227], v[48:51], v[112:115]
    ds_read_b64_tr_b16 v[214:215], v246 offset:34816
    v_mfma_f32_16x16x32_bf16 v[116:119], v[228:231], v[48:51], v[116:119]
    ds_read_b64_tr_b16 v[216:217], v247 offset:32768
    buffer_load_dwordx4 v[176:179], v248, s[12:15], s70 offen offset:1024 sc1
    v_mfma_f32_16x16x32_bf16 v[120:123], v[232:235], v[48:51], v[120:123]
    ds_read_b64_tr_b16 v[218:219], v247 offset:34816
    v_mfma_f32_16x16x32_bf16 v[124:127], v[220:223], v[52:55], v[124:127]
    v_mfma_f32_16x16x32_bf16 v[128:131], v[224:227], v[52:55], v[128:131]
    v_mfma_f32_16x16x32_bf16 v[132:135], v[228:231], v[52:55], v[132:135]
    buffer_load_dwordx4 v[180:183], v248, s[12:15], s70 offen offset:2048 sc1
    v_mfma_f32_16x16x32_bf16 v[136:139], v[232:235], v[52:55], v[136:139]
    v_mfma_f32_16x16x32_bf16 v[140:143], v[220:223], v[56:59], v[140:143]
    v_mfma_f32_16x16x32_bf16 v[144:147], v[224:227], v[56:59], v[144:147]
    v_mfma_f32_16x16x32_bf16 v[148:151], v[228:231], v[56:59], v[148:151]
    buffer_load_dwordx4 v[184:187], v248, s[12:15], s70 offen offset:3072 sc1
    v_mfma_f32_16x16x32_bf16 v[152:155], v[232:235], v[56:59], v[152:155]
    s_waitcnt vmcnt(12)
    s_waitcnt lgkmcnt(8)
    v_mfma_f32_16x16x32_bf16 v[92:95], v[188:191], v[60:63], v[92:95]
    v_xor_b32 v244, 65536, v244
    v_mfma_f32_16x16x32_bf16 v[96:99], v[192:195], v[60:63], v[96:99]
    v_xor_b32 v245, 65536, v245
    v_mfma_f32_16x16x32_bf16 v[100:103], v[196:199], v[60:63], v[100:103]
    v_xor_b32 v246, 65536, v246
    v_mfma_f32_16x16x32_bf16 v[104:107], v[200:203], v[60:63], v[104:107]
    v_xor_b32 v247, 65536, v247
    v_mfma_f32_16x16x32_bf16 v[108:111], v[188:191], v[64:67], v[108:111]
    ds_read_b64_tr_b16 v[220:221], v244 offset:0
    v_mfma_f32_16x16x32_bf16 v[112:115], v[192:195], v[64:67], v[112:115]
    ds_read_b64_tr_b16 v[222:223], v244 offset:2048
    v_mfma_f32_16x16x32_bf16 v[116:119], v[196:199], v[64:67], v[116:119]
    ds_read_b64_tr_b16 v[224:225], v245 offset:0
    v_mfma_f32_16x16x32_bf16 v[120:123], v[200:203], v[64:67], v[120:123]
    ds_read_b64_tr_b16 v[226:227], v245 offset:2048
    v_mfma_f32_16x16x32_bf16 v[124:127], v[188:191], v[68:71], v[124:127]
    ds_read_b64_tr_b16 v[228:229], v246 offset:0
    v_mfma_f32_16x16x32_bf16 v[128:131], v[192:195], v[68:71], v[128:131]
    ds_read_b64_tr_b16 v[230:231], v246 offset:2048
    v_mfma_f32_16x16x32_bf16 v[132:135], v[196:199], v[68:71], v[132:135]
    ds_read_b64_tr_b16 v[232:233], v247 offset:0
    v_mfma_f32_16x16x32_bf16 v[136:139], v[200:203], v[68:71], v[136:139]
    ds_read_b64_tr_b16 v[234:235], v247 offset:2048
    v_mfma_f32_16x16x32_bf16 v[140:143], v[188:191], v[72:75], v[140:143]
    v_mfma_f32_16x16x32_bf16 v[144:147], v[192:195], v[72:75], v[144:147]
    v_mfma_f32_16x16x32_bf16 v[148:151], v[196:199], v[72:75], v[148:151]
    v_mfma_f32_16x16x32_bf16 v[152:155], v[200:203], v[72:75], v[152:155]
    s_waitcnt vmcnt(8)
    s_waitcnt lgkmcnt(8)
    v_mfma_f32_16x16x32_bf16 v[92:95], v[204:207], v[76:79], v[92:95]
    ds_read_b64_tr_b16 v[188:189], v244 offset:32768
    v_mfma_f32_16x16x32_bf16 v[96:99], v[208:211], v[76:79], v[96:99]
    ds_read_b64_tr_b16 v[190:191], v244 offset:34816
    v_mfma_f32_16x16x32_bf16 v[100:103], v[212:215], v[76:79], v[100:103]
    ds_read_b64_tr_b16 v[192:193], v245 offset:32768
    v_mfma_f32_16x16x32_bf16 v[104:107], v[216:219], v[76:79], v[104:107]
    ds_read_b64_tr_b16 v[194:195], v245 offset:34816
    v_mfma_f32_16x16x32_bf16 v[108:111], v[204:207], v[80:83], v[108:111]
    ds_read_b64_tr_b16 v[196:197], v246 offset:32768
    buffer_load_dwordx4 v[236:239], v250, s[4:7], 0 offen
    v_mfma_f32_16x16x32_bf16 v[112:115], v[208:211], v[80:83], v[112:115]
    ds_read_b64_tr_b16 v[198:199], v246 offset:34816
    v_mfma_f32_16x16x32_bf16 v[116:119], v[212:215], v[80:83], v[116:119]
    ds_read_b64_tr_b16 v[200:201], v247 offset:32768
    v_mfma_f32_16x16x32_bf16 v[120:123], v[216:219], v[80:83], v[120:123]
    ds_read_b64_tr_b16 v[202:203], v247 offset:34816
    v_mfma_f32_16x16x32_bf16 v[124:127], v[204:207], v[84:87], v[124:127]
    v_mfma_f32_16x16x32_bf16 v[128:131], v[208:211], v[84:87], v[128:131]
    v_mfma_f32_16x16x32_bf16 v[132:135], v[212:215], v[84:87], v[132:135]
    v_mfma_f32_16x16x32_bf16 v[136:139], v[216:219], v[84:87], v[136:139]
    v_mfma_f32_16x16x32_bf16 v[140:143], v[204:207], v[88:91], v[140:143]
    buffer_load_dwordx4 v[240:243], v251, s[28:31], 0 offen
    v_mfma_f32_16x16x32_bf16 v[144:147], v[208:211], v[88:91], v[144:147]
    v_mfma_f32_16x16x32_bf16 v[148:151], v[212:215], v[88:91], v[148:151]
    v_mfma_f32_16x16x32_bf16 v[152:155], v[216:219], v[88:91], v[152:155]
    s_waitcnt vmcnt(6)
    s_waitcnt lgkmcnt(8)
    v_mfma_f32_16x16x32_bf16 v[92:95], v[220:223], v[156:159], v[92:95]
    v_xor_b32 v12, v2, v1
    v_mfma_f32_16x16x32_bf16 v[96:99], v[224:227], v[156:159], v[96:99]
    v_lshlrev_b32 v12, 4, v12
    v_mfma_f32_16x16x32_bf16 v[100:103], v[228:231], v[156:159], v[100:103]
    v_lshl_add_u32 v12, v1, 8, v12
    v_mfma_f32_16x16x32_bf16 v[104:107], v[232:235], v[156:159], v[104:107]
    v_add_u32 v12, s58, v12
    v_mfma_f32_16x16x32_bf16 v[108:111], v[220:223], v[160:163], v[108:111]
    v_xor_b32 v13, 64, v12
    v_mfma_f32_16x16x32_bf16 v[112:115], v[224:227], v[160:163], v[112:115]
    v_xor_b32 v14, 128, v12
    v_mfma_f32_16x16x32_bf16 v[116:119], v[228:231], v[160:163], v[116:119]
    v_xor_b32 v15, 192, v12
    v_mfma_f32_16x16x32_bf16 v[120:123], v[232:235], v[160:163], v[120:123]
    v_add_u32 v16, 0x10000, v12
    v_mfma_f32_16x16x32_bf16 v[124:127], v[220:223], v[164:167], v[124:127]
    buffer_load_dword v8, v253, s[12:15], 0 offen sc1
    v_add_u32 v17, 0x10000, v13
    v_mfma_f32_16x16x32_bf16 v[128:131], v[224:227], v[164:167], v[128:131]
    v_add_u32 v18, 0x10000, v14
    v_mfma_f32_16x16x32_bf16 v[132:135], v[228:231], v[164:167], v[132:135]
    v_add_u32 v19, 0x10000, v15
    v_mfma_f32_16x16x32_bf16 v[136:139], v[232:235], v[164:167], v[136:139]
    v_mfma_f32_16x16x32_bf16 v[140:143], v[220:223], v[168:171], v[140:143]
    v_mfma_f32_16x16x32_bf16 v[144:147], v[224:227], v[168:171], v[144:147]
    v_mfma_f32_16x16x32_bf16 v[148:151], v[228:231], v[168:171], v[148:151]
    v_mfma_f32_16x16x32_bf16 v[152:155], v[232:235], v[168:171], v[152:155]
    s_waitcnt vmcnt(0)
    s_mov_b32 s61, 0x40000
L_poll_53:
    v_cmp_ne_u32 vcc, v255, v8
    s_nop 0
    s_cmp_eq_u64 vcc, 0
    s_cbranch_scc1 L_polled_54
    s_sleep 10
    buffer_load_dword v8, v253, s[12:15], 0 offen sc1
    s_waitcnt vmcnt(0)
    s_sub_u32 s61, s61, 1
    s_cbranch_scc0 L_poll_53
L_polled_54:
    v_mov_b32 v10, 152608
    v_mov_b32 v11, 1
    s_mov_b64 exec, 1
    ds_add_u32 v10, v11
    s_mov_b64 exec, -1
    s_waitcnt lgkmcnt(0)
    v_mov_b32 v10, 152588
L_lw_55:
    ds_read_b32 v11, v10
    s_waitcnt lgkmcnt(0)
    v_cmp_ne_u32 vcc, 4, v11
    s_nop 0
    s_cmp_eq_u64 vcc, 0
    s_cbranch_scc1 L_lwd_56
    s_sleep 1
    s_branch L_lw_55
L_lwd_56:
    v_mov_b32 v10, 152592
    v_mov_b32 v11, 1
    s_mov_b64 exec, 1
    ds_add_u32 v10, v11
    s_mov_b64 exec, -1
    s_waitcnt lgkmcnt(0)
    v_mfma_f32_16x16x32_bf16 v[92:95], v[188:191], v[172:175], v[92:95]
    v_mfma_f32_16x16x32_bf16 v[96:99], v[192:195], v[172:175], v[96:99]
    v_mfma_f32_16x16x32_bf16 v[100:103], v[196:199], v[172:175], v[100:103]
    v_mfma_f32_16x16x32_bf16 v[104:107], v[200:203], v[172:175], v[104:107]
    v_mfma_f32_16x16x32_bf16 v[108:111], v[188:191], v[176:179], v[108:111]
    s_nop 3
    ds_write_b128 v12, v[92:95] offset:0
    v_mfma_f32_16x16x32_bf16 v[112:115], v[192:195], v[176:179], v[112:115]
    ds_write_b128 v13, v[96:99] offset:0
    v_mfma_f32_16x16x32_bf16 v[116:119], v[196:199], v[176:179], v[116:119]
    ds_write_b128 v14, v[100:103] offset:0
    v_mfma_f32_16x16x32_bf16 v[120:123], v[200:203], v[176:179], v[120:123]
    ds_write_b128 v15, v[104:107] offset:0
    v_mfma_f32_16x16x32_bf16 v[124:127], v[188:191], v[180:183], v[124:127]
    ds_write_b128 v12, v[108:111] offset:32768
    v_mfma_f32_16x16x32_bf16 v[128:131], v[192:195], v[180:183], v[128:131]
    ds_write_b128 v13, v[112:115] offset:32768
    v_mfma_f32_16x16x32_bf16 v[132:135], v[196:199], v[180:183], v[132:135]
    ds_write_b128 v14, v[116:119] offset:32768
    v_mfma_f32_16x16x32_bf16 v[136:139], v[200:203], v[180:183], v[136:139]
    ds_write_b128 v15, v[120:123] offset:32768
    v_mfma_f32_16x16x32_bf16 v[140:143], v[188:191], v[184:187], v[140:143]
    ds_write_b128 v16, v[124:127] offset:0
    v_mfma_f32_16x16x32_bf16 v[144:147], v[192:195], v[184:187], v[144:147]
    ds_write_b128 v17, v[128:131] offset:0
    v_mfma_f32_16x16x32_bf16 v[148:151], v[196:199], v[184:187], v[148:151]
    ds_write_b128 v18, v[132:135] offset:0
    v_mfma_f32_16x16x32_bf16 v[152:155], v[200:203], v[184:187], v[152:155]
    ds_write_b128 v19, v[136:139] offset:0
    s_nop 0
    ds_write_b128 v16, v[140:143] offset:32768
    s_nop 0
    ds_write_b128 v17, v[144:147] offset:32768
    s_nop 0
    ds_write_b128 v18, v[148:151] offset:32768
    s_nop 0
    ds_write_b128 v19, v[152:155] offset:32768
    v_lshrrev_b32 v22, 3, v0
    v_and_b32 v23, 7, v0
    v_lshlrev_b32 v23, 1, v23
    v_xor_b32 v23, v23, v22
    v_lshlrev_b32 v23, 4, v23
    v_lshl_add_u32 v22, v22, 8, v23
    v_lshl_add_u32 v22, s49, 15, v22
    v_xor_b32 v23, 16, v22
    v_xor_b32 v24, 2176, v22
    v_xor_b32 v25, 2176, v23
    s_lshl2_add_u32 s52, s2, s49
    s_lshl_b32 s52, s52, 11
    s_add_u32 s52, s52, 16777216
    v_lshlrev_b32 v26, 4, v0
    s_waitcnt lgkmcnt(0)
    v_mov_b32 v20, 152596
    v_mov_b32 v21, 1
    s_mov_b64 exec, 1
    ds_add_u32 v20, v21
    s_mov_b64 exec, -1
    v_mov_b32 v20, 152596
L_lw_57:
    ds_read_b32 v21, v20
    s_waitcnt lgkmcnt(0)
    v_cmp_ne_u32 vcc, 4, v21
    s_nop 0
    s_cmp_eq_u64 vcc, 0
    s_cbranch_scc1 L_lwd_58
    s_branch L_lw_57
L_lwd_58:
    ds_read_b128 v[92:95], v22 offset:16384
    ds_read_b128 v[96:99], v23 offset:16384
    ds_read_b128 v[100:103], v22 offset:20480
    ds_read_b128 v[104:107], v23 offset:20480
    ds_read_b128 v[108:111], v22 offset:24576
    ds_read_b128 v[112:115], v23 offset:24576
    ds_read_b128 v[116:119], v22 offset:28672
    ds_read_b128 v[120:123], v23 offset:28672
    ds_read_b128 v[124:127], v24 offset:16384
    ds_read_b128 v[128:131], v25 offset:16384
    ds_read_b128 v[132:135], v24 offset:20480
    ds_read_b128 v[136:139], v25 offset:20480
    ds_read_b128 v[140:143], v24 offset:24576
    ds_read_b128 v[144:147], v25 offset:24576
    ds_read_b128 v[148:151], v24 offset:28672
    ds_read_b128 v[152:155], v25 offset:28672
    s_waitcnt lgkmcnt(8)
    v_add_f32 v92, v92, v100
    v_add_f32 v108, v108, v116
    v_add_f32 v93, v93, v101
    v_add_f32 v109, v109, v117
    v_add_f32 v94, v94, v102
    v_add_f32 v110, v110, v118
    v_add_f32 v95, v95, v103
    v_add_f32 v111, v111, v119
    v_add_f32 v96, v96, v104
    v_add_f32 v112, v112, v120
    v_add_f32 v97, v97, v105
    v_add_f32 v113, v113, v121
    v_add_f32 v98, v98, v106
    v_add_f32 v114, v114, v122
    v_add_f32 v99, v99, v107
    v_add_f32 v115, v115, v123
    v_add_f32 v92, v92, v108
    v_add_f32 v93, v93, v109
    v_add_f32 v94, v94, v110
    v_add_f32 v95, v95, v111
    v_add_f32 v96, v96, v112
    v_add_f32 v97, v97, v113
    v_add_f32 v98, v98, v114
    v_add_f32 v99, v99, v115
    v_cvt_pk_bf16_f32 v28, v92, v93
    v_cvt_pk_bf16_f32 v29, v94, v95
    v_cvt_pk_bf16_f32 v30, v96, v97
    v_cvt_pk_bf16_f32 v31, v98, v99
    buffer_store_dwordx4 v[28:31], v26, s[12:15], s52 offen offset:0 sc1
    s_waitcnt lgkmcnt(0)
    v_add_f32 v124, v124, v132
    v_add_f32 v140, v140, v148
    v_add_f32 v125, v125, v133
    v_add_f32 v141, v141, v149
    v_add_f32 v126, v126, v134
    v_add_f32 v142, v142, v150
    v_add_f32 v127, v127, v135
    v_add_f32 v143, v143, v151
    v_add_f32 v128, v128, v136
    v_add_f32 v144, v144, v152
    v_add_f32 v129, v129, v137
    v_add_f32 v145, v145, v153
    v_add_f32 v130, v130, v138
    v_add_f32 v146, v146, v154
    v_add_f32 v131, v131, v139
    v_add_f32 v147, v147, v155
    v_add_f32 v124, v124, v140
    v_add_f32 v125, v125, v141
    v_add_f32 v126, v126, v142
    v_add_f32 v127, v127, v143
    v_add_f32 v128, v128, v144
    v_add_f32 v129, v129, v145
    v_add_f32 v130, v130, v146
    v_add_f32 v131, v131, v147
    v_cvt_pk_bf16_f32 v32, v124, v125
    v_cvt_pk_bf16_f32 v33, v126, v127
    v_cvt_pk_bf16_f32 v34, v128, v129
    v_cvt_pk_bf16_f32 v35, v130, v131
    buffer_store_dwordx4 v[32:35], v26, s[12:15], s52 offen offset:1024 sc1
L_red_13:
    s_xor_b32 s54, s2, 1
    s_lshl3_add_u32 s54, s54, s44
    s_lshl_b32 s54, s54, 10
    s_add_u32 s54, s54, 16777216
    v_lshl_add_u32 v248, v0, 4, s54
    buffer_load_dwordx4 v[88:91], v248, s[12:15], 0 offen sc1
    v_lshrrev_b32 v76, 3, v0
    s_and_b32 s52, s44, 1
    v_lshl_add_u32 v76, s52, 3, v76
    v_and_b32 v77, 7, v0
    v_lshlrev_b32 v77, 1, v77
    v_xor_b32 v77, v77, v76
    v_lshlrev_b32 v77, 4, v77
    v_lshl_add_u32 v76, v76, 8, v77
    s_lshr_b32 s52, s44, 1
    s_lshl_b32 s52, s52, 15
    v_add_u32 v76, s52, v76
    v_xor_b32 v77, 16, v76
    s_waitcnt vmcnt(1)
    v_lshlrev_b32 v220, 16, v236
    v_and_b32 v221, 0xffff0000, v236
    v_lshlrev_b32 v228, 16, v240
    v_and_b32 v229, 0xffff0000, v240
    v_lshlrev_b32 v222, 16, v237
    v_and_b32 v223, 0xffff0000, v237
    v_lshlrev_b32 v230, 16, v241
    v_and_b32 v231, 0xffff0000, v241
    v_lshlrev_b32 v224, 16, v238
    v_and_b32 v225, 0xffff0000, v238
    v_lshlrev_b32 v232, 16, v242
    v_and_b32 v233, 0xffff0000, v242
    v_lshlrev_b32 v226, 16, v239
    v_and_b32 v227, 0xffff0000, v239
    v_lshlrev_b32 v234, 16, v243
    v_and_b32 v235, 0xffff0000, v243
    v_add_f32 v80, v220, v228
    v_add_f32 v81, v221, v229
    v_add_f32 v82, v222, v230
    v_add_f32 v83, v223, v231
    v_add_f32 v84, v224, v232
    v_add_f32 v85, v225, v233
    v_add_f32 v86, v226, v234
    v_add_f32 v87, v227, v235
    s_waitcnt lgkmcnt(0)
    s_barrier
    ds_read_b128 v[12:15], v76 offset:0
    ds_read_b128 v[16:19], v77 offset:0
    ds_read_b128 v[20:23], v76 offset:4096
    ds_read_b128 v[24:27], v77 offset:4096
    ds_read_b128 v[28:31], v76 offset:8192
    ds_read_b128 v[32:35], v77 offset:8192
    ds_read_b128 v[36:39], v76 offset:12288
    ds_read_b128 v[40:43], v77 offset:12288
    s_waitcnt lgkmcnt(6)
    v_add_f32 v80, v80, v12
    v_add_f32 v81, v81, v13
    v_add_f32 v82, v82, v14
    v_add_f32 v83, v83, v15
    v_add_f32 v84, v84, v16
    v_add_f32 v85, v85, v17
    v_add_f32 v86, v86, v18
    v_add_f32 v87, v87, v19
    s_waitcnt lgkmcnt(4)
    v_add_f32 v80, v80, v20
    v_add_f32 v81, v81, v21
    v_add_f32 v82, v82, v22
    v_add_f32 v83, v83, v23
    v_add_f32 v84, v84, v24
    v_add_f32 v85, v85, v25
    v_add_f32 v86, v86, v26
    v_add_f32 v87, v87, v27
    s_waitcnt lgkmcnt(2)
    v_add_f32 v80, v80, v28
    v_add_f32 v81, v81, v29
    v_add_f32 v82, v82, v30
    v_add_f32 v83, v83, v31
    v_add_f32 v84, v84, v32
    v_add_f32 v85, v85, v33
    v_add_f32 v86, v86, v34
    v_add_f32 v87, v87, v35
    s_waitcnt lgkmcnt(0)
    v_add_f32 v80, v80, v36
    v_add_f32 v81, v81, v37
    v_add_f32 v82, v82, v38
    v_add_f32 v83, v83, v39
    v_add_f32 v84, v84, v40
    v_add_f32 v85, v85, v41
    v_add_f32 v86, v86, v42
    v_add_f32 v87, v87, v43
    s_waitcnt vmcnt(0)
    s_mov_b32 s61, 0x40000
L_sp_59:
    v_max3_u32 v220, v88, v89, v90
    v_max_u32 v220, v220, v91
    v_cmp_eq_u32 vcc, -1, v220
    s_nop 0
    s_cmp_eq_u64 vcc, 0
    s_cbranch_scc1 L_sd_60
    s_sleep 4
    buffer_load_dwordx4 v[88:91], v248, s[12:15], 0 offen sc1
    s_waitcnt vmcnt(0)
    s_sub_u32 s61, s61, 1
    s_cbranch_scc0 L_sp_59
L_sd_60:
    v_lshlrev_b32 v220, 16, v88
    v_and_b32 v221, 0xffff0000, v88
    v_lshlrev_b32 v222, 16, v89
    v_and_b32 v223, 0xffff0000, v89
    v_lshlrev_b32 v224, 16, v90
    v_and_b32 v225, 0xffff0000, v90
    v_lshlrev_b32 v226, 16, v91
    v_and_b32 v227, 0xffff0000, v91
    v_add_f32 v80, v80, v220
    v_add_f32 v81, v81, v221
    v_add_f32 v82, v82, v222
    v_add_f32 v83, v83, v223
    v_add_f32 v84, v84, v224
    v_add_f32 v85, v85, v225
    v_add_f32 v86, v86, v226
    v_add_f32 v87, v87, v227
    v_cvt_pk_bf16_f32 v220, v80, v81
    v_cvt_pk_bf16_f32 v221, v82, v83
    v_cvt_pk_bf16_f32 v222, v84, v85
    v_cvt_pk_bf16_f32 v223, v86, v87
    buffer_store_dwordx4 v[220:223], v250, s[32:35], 0 offen
    s_or_b32 s52, s2, s44
    s_cmp_eq_u32 s52, 0
    s_cbranch_scc0 L_noep_61
    v_mov_b32 v253, 14680064
    s_mov_b64 exec, 1
    buffer_store_dword v255, v253, s[12:15], 0 offen sc1
    s_mov_b64 exec, -1
L_noep_61:
L_fin:
L_end:
    s_endpgm

.section .rodata,"a"
.p2align 6
.amdhsa_kernel parallel_sum__spectral_gfnet__mixer_channel_mlp__prompt_kernel
  .amdhsa_next_free_vgpr 256
  .amdhsa_next_free_sgpr 102
  .amdhsa_accum_offset 256
  .amdhsa_group_segment_fixed_size 0
  .amdhsa_kernarg_size 88
  .amdhsa_user_sgpr_count 2
  .amdhsa_user_sgpr_kernarg_segment_ptr 1
  .amdhsa_system_sgpr_workgroup_id_x 1
.end_amdhsa_kernel
```
